```python
import torch

def _softmax(x, axis=-1):
    return torch.softmax(x, dim=axis)
def _gelu(x):
    return torch.nn.functional.gelu(x, approximate="tanh")
def _silu(x):
    return torch.nn.functional.silu(x)
def _sigmoid(x):
    return torch.sigmoid(x)
def _layernorm(x, axis=-1, eps=1e-5):
    m = x.mean(dim=axis, keepdim=True)
    v = x.var(dim=axis, keepdim=True, unbiased=False)
    return (x - m) / torch.sqrt(v + eps)
def _scatter_add(tgt, idx, src, axis=0):
    return tgt.clone().index_add_(axis, idx, src)
def _segment_sum(src, seg, n):
    out = torch.zeros((n,) + src.shape[1:], dtype=src.dtype)
    return out.index_add_(0, seg, src)
def _pad(x, pw):
    flat = tuple(v for pair in reversed(pw) for v in pair)
    return torch.nn.functional.pad(x, flat)

kernel_name = 'standalone__mha_block_cached__near_ridge'

def setup_inputs():

    _w = (lambda a: (lambda t: t.to(torch.bfloat16) if t.is_floating_point() else t)(torch.as_tensor(a)))
    B, Sq, D = 32, 32, 576
    H, Sk, Dh = 32, 32, 128
    return {
        "x": _w((lambda *s: torch.randn(*s, dtype=torch.bfloat16) * 0.8)(B, Sq, D)),
        "k_cache": _w((lambda *s: torch.randn(*s, dtype=torch.bfloat16) * 0.8)(B, H, Sk, Dh)),
        "v_cache": _w((lambda *s: torch.randn(*s, dtype=torch.bfloat16) * 0.05)(B, H, Sk, Dh)),
        "wq": _w((lambda *s: torch.randn(*s, dtype=torch.bfloat16) * 0.8)(D, H * Dh) * (D ** -0.5)),
        "wo": _w((lambda *s: torch.randn(*s, dtype=torch.bfloat16) * 0.05)(H * Dh, D) * ((H * Dh) ** -0.5)),
    }

def reference(x, k_cache, v_cache, wq, wo):
    B, Sq, D = x.shape
    H, Dh = 32, 128
    q = (lambda x, *d: x.permute(*d))((x @ wq).reshape(B, Sq, H, Dh), 0, 2, 1, 3)
    scores = torch.einsum("bhqd,bhkd->bhqk", q, k_cache) * (Dh ** -0.5)
    p = _softmax(scores, axis=-1)
    o = torch.einsum("bhqk,bhkd->bhqd", p, v_cache)
    return (lambda x, *d: x.permute(*d))(o, 0, 2, 1, 3).reshape(B, Sq, H * Dh) @ wo
```

```asm
; @launch grid=(256,1,1) block=(512,1,1) lds=163840
.amdgcn_target "amdgcn-amd-amdhsa--gfx950"
.text
.p2align 8
.globl standalone__mha_block_cached__near_ridge_kernel
.type standalone__mha_block_cached__near_ridge_kernel,@function
standalone__mha_block_cached__near_ridge_kernel:
  s_cmp_ge_u32 s2, 256
  s_cbranch_scc1 L_end_standalone__mha_block_cached__near_ridge_kernel
  s_load_dwordx16 s[16:31], s[0:1], 0
  v_lshrrev_b32 v1, 6, v0
  v_and_b32 v0, 63, v0
  s_and_b32 s4, s2, 7
  s_lshr_b32 s5, s2, 3
  v_readfirstlane_b32 s3, v1
  s_and_b32 s6, s5, 3
  s_lshr_b32 s9, s5, 2
  s_lshl_b32 s10, s4, 2
  s_add_u32 s10, s10, s6
  s_cmp_lt_u32 s3, 4
  s_cbranch_scc1 L_a_compute
  s_cmp_eq_u32 s3, 5
  s_cbranch_scc1 L_a_ldx
  s_cmp_eq_u32 s3, 6
  s_cbranch_scc1 L_a_ldk
  s_cmp_eq_u32 s3, 7
  s_cbranch_scc1 L_a_ldv
  v_lshrrev_b32 v1, 4, v0
  v_and_b32 v2, 15, v0
  v_lshlrev_b32 v3, 2, v1
  v_xor_b32 v3, v3, v2
  v_lshlrev_b32 v3, 4, v3
  v_lshlrev_b32 v4, 13, v1
  v_add_u32 v4, v4, v3
  s_lshl_b32 s40, s10, 8
  s_and_b32 s43, s9, 3
  s_lshl_b32 s43, s43, 2
  s_lshr_b32 s43, 30000, s43
  s_and_b32 s43, s43, 15
  v_lshrrev_b32 v8, 1, v0
  v_and_b32 v9, 1, v0
  v_lshlrev_b32 v8, 13, v8
  v_lshl_add_u32 v8, v9, 7, v8
  s_lshl_b32 s46, s9, 18
  s_lshl_b32 s47, s10, 8
  s_add_u32 s46, s46, s47
  s_waitcnt lgkmcnt(0)
  s_mov_b32 s32, s22
  s_and_b32 s33, s23, 0xffff
  s_mov_b32 s34, 4718592
  s_mov_b32 s35, 0x00020000
  buffer_load_dword v10, v8, s[32:35], s46 offen
  s_mov_b32 m0, 0
  s_nop 0
  buffer_load_dwordx4 v4, s[32:35], s40 offen lds
  s_add_u32 s40, s40, 32768
  s_add_u32 m0, m0, 1024
  s_nop 0
  buffer_load_dwordx4 v4, s[32:35], s40 offen lds
  s_add_u32 s40, s40, 32768
  s_add_u32 m0, m0, 1024
  s_nop 0
  buffer_load_dwordx4 v4, s[32:35], s40 offen lds
  s_add_u32 s40, s40, 32768
  s_add_u32 m0, m0, 1024
  s_nop 0
  buffer_load_dwordx4 v4, s[32:35], s40 offen lds
  s_add_u32 s40, s40, 32768
  s_add_u32 m0, m0, 1024
  s_nop 0
  buffer_load_dwordx4 v4, s[32:35], s40 offen lds
  s_add_u32 s40, s40, 32768
  s_add_u32 m0, m0, 1024
  s_nop 0
  buffer_load_dwordx4 v4, s[32:35], s40 offen lds
  s_add_u32 s40, s40, 32768
  s_add_u32 m0, m0, 1024
  s_nop 0
  buffer_load_dwordx4 v4, s[32:35], s40 offen lds
  s_add_u32 s40, s40, 32768
  s_add_u32 m0, m0, 1024
  s_nop 0
  buffer_load_dwordx4 v4, s[32:35], s40 offen lds
  s_add_u32 s40, s40, 32768
  s_add_u32 m0, m0, 1024
  s_nop 0
  buffer_load_dwordx4 v4, s[32:35], s40 offen lds
  s_add_u32 s40, s40, 32768
  s_add_u32 m0, m0, 1024
  s_nop 0
  buffer_load_dwordx4 v4, s[32:35], s40 offen lds
  s_add_u32 s40, s40, 32768
  s_add_u32 m0, m0, 1024
  s_nop 0
  buffer_load_dwordx4 v4, s[32:35], s40 offen lds
  s_add_u32 s40, s40, 32768
  s_add_u32 m0, m0, 1024
  s_nop 0
  buffer_load_dwordx4 v4, s[32:35], s40 offen lds
  s_add_u32 s40, s40, 32768
  s_add_u32 m0, m0, 1024
  s_nop 0
  buffer_load_dwordx4 v4, s[32:35], s40 offen lds
  s_add_u32 s40, s40, 32768
  s_add_u32 m0, m0, 1024
  s_nop 0
  buffer_load_dwordx4 v4, s[32:35], s40 offen lds
  s_add_u32 s40, s40, 32768
  s_add_u32 m0, m0, 1024
  s_nop 0
  buffer_load_dwordx4 v4, s[32:35], s40 offen lds
  s_add_u32 s40, s40, 32768
  s_add_u32 m0, m0, 1024
  s_nop 0
  buffer_load_dwordx4 v4, s[32:35], s40 offen lds
  s_add_u32 s40, s40, 32768
  s_add_u32 s46, s46, 2097152
  buffer_load_dword v10, v8, s[32:35], s46 offen
  s_lshl_b32 s46, s9, 16
  s_add_u32 s46, s46, s47
  s_add_u32 s46, s46, 4194304
  s_mov_b64 exec, 0xffff
  buffer_load_dword v10, v8, s[32:35], s46 offen
  s_mov_b64 exec, -1
  s_barrier
  s_cmp_lg_u32 s43, 0
  s_cbranch_scc1 L_bx_rwq_0
  s_barrier
L_bx_rwq_0:
  s_mov_b32 m0, 32768
  s_nop 0
  buffer_load_dwordx4 v4, s[32:35], s40 offen lds
  s_add_u32 s40, s40, 32768
  s_add_u32 m0, m0, 1024
  s_nop 0
  buffer_load_dwordx4 v4, s[32:35], s40 offen lds
  s_add_u32 s40, s40, 32768
  s_add_u32 m0, m0, 1024
  s_nop 0
  buffer_load_dwordx4 v4, s[32:35], s40 offen lds
  s_add_u32 s40, s40, 32768
  s_add_u32 m0, m0, 1024
  s_nop 0
  buffer_load_dwordx4 v4, s[32:35], s40 offen lds
  s_add_u32 s40, s40, 32768
  s_add_u32 m0, m0, 1024
  s_nop 0
  buffer_load_dwordx4 v4, s[32:35], s40 offen lds
  s_add_u32 s40, s40, 32768
  s_add_u32 m0, m0, 1024
  s_nop 0
  buffer_load_dwordx4 v4, s[32:35], s40 offen lds
  s_add_u32 s40, s40, 32768
  s_add_u32 m0, m0, 1024
  s_nop 0
  buffer_load_dwordx4 v4, s[32:35], s40 offen lds
  s_add_u32 s40, s40, 32768
  s_add_u32 m0, m0, 1024
  s_nop 0
  buffer_load_dwordx4 v4, s[32:35], s40 offen lds
  s_add_u32 s40, s40, 32768
  s_add_u32 m0, m0, 1024
  s_nop 0
  buffer_load_dwordx4 v4, s[32:35], s40 offen lds
  s_add_u32 s40, s40, 32768
  s_add_u32 m0, m0, 1024
  s_nop 0
  buffer_load_dwordx4 v4, s[32:35], s40 offen lds
  s_add_u32 s40, s40, 32768
  s_add_u32 m0, m0, 1024
  s_nop 0
  buffer_load_dwordx4 v4, s[32:35], s40 offen lds
  s_add_u32 s40, s40, 32768
  s_add_u32 m0, m0, 1024
  s_nop 0
  buffer_load_dwordx4 v4, s[32:35], s40 offen lds
  s_add_u32 s40, s40, 32768
  s_add_u32 m0, m0, 1024
  s_nop 0
  buffer_load_dwordx4 v4, s[32:35], s40 offen lds
  s_add_u32 s40, s40, 32768
  s_add_u32 m0, m0, 1024
  s_nop 0
  buffer_load_dwordx4 v4, s[32:35], s40 offen lds
  s_add_u32 s40, s40, 32768
  s_add_u32 m0, m0, 1024
  s_nop 0
  buffer_load_dwordx4 v4, s[32:35], s40 offen lds
  s_add_u32 s40, s40, 32768
  s_add_u32 m0, m0, 1024
  s_nop 0
  buffer_load_dwordx4 v4, s[32:35], s40 offen lds
  s_add_u32 s40, s40, 32768
  s_waitcnt vmcnt(18)
  s_barrier
  s_cmp_lg_u32 s43, 1
  s_cbranch_scc1 L_bx_rwq_1
  s_barrier
L_bx_rwq_1:
  s_mov_b32 m0, 65536
  s_nop 0
  buffer_load_dwordx4 v4, s[32:35], s40 offen lds
  s_add_u32 s40, s40, 32768
  s_add_u32 m0, m0, 1024
  s_nop 0
  buffer_load_dwordx4 v4, s[32:35], s40 offen lds
  s_add_u32 s40, s40, 32768
  s_add_u32 m0, m0, 1024
  s_nop 0
  buffer_load_dwordx4 v4, s[32:35], s40 offen lds
  s_add_u32 s40, s40, 32768
  s_add_u32 m0, m0, 1024
  s_nop 0
  buffer_load_dwordx4 v4, s[32:35], s40 offen lds
  s_add_u32 s40, s40, 32768
  s_add_u32 m0, m0, 1024
  s_nop 0
  buffer_load_dwordx4 v4, s[32:35], s40 offen lds
  s_add_u32 s40, s40, 32768
  s_add_u32 m0, m0, 1024
  s_nop 0
  buffer_load_dwordx4 v4, s[32:35], s40 offen lds
  s_add_u32 s40, s40, 32768
  s_add_u32 m0, m0, 1024
  s_nop 0
  buffer_load_dwordx4 v4, s[32:35], s40 offen lds
  s_add_u32 s40, s40, 32768
  s_add_u32 m0, m0, 1024
  s_nop 0
  buffer_load_dwordx4 v4, s[32:35], s40 offen lds
  s_add_u32 s40, s40, 32768
  s_add_u32 m0, m0, 1024
  s_nop 0
  buffer_load_dwordx4 v4, s[32:35], s40 offen lds
  s_add_u32 s40, s40, 32768
  s_add_u32 m0, m0, 1024
  s_nop 0
  buffer_load_dwordx4 v4, s[32:35], s40 offen lds
  s_add_u32 s40, s40, 32768
  s_add_u32 m0, m0, 1024
  s_nop 0
  buffer_load_dwordx4 v4, s[32:35], s40 offen lds
  s_add_u32 s40, s40, 32768
  s_add_u32 m0, m0, 1024
  s_nop 0
  buffer_load_dwordx4 v4, s[32:35], s40 offen lds
  s_add_u32 s40, s40, 32768
  s_add_u32 m0, m0, 1024
  s_nop 0
  buffer_load_dwordx4 v4, s[32:35], s40 offen lds
  s_add_u32 s40, s40, 32768
  s_add_u32 m0, m0, 1024
  s_nop 0
  buffer_load_dwordx4 v4, s[32:35], s40 offen lds
  s_add_u32 s40, s40, 32768
  s_add_u32 m0, m0, 1024
  s_nop 0
  buffer_load_dwordx4 v4, s[32:35], s40 offen lds
  s_add_u32 s40, s40, 32768
  s_add_u32 m0, m0, 1024
  s_nop 0
  buffer_load_dwordx4 v4, s[32:35], s40 offen lds
  s_add_u32 s40, s40, 32768
  s_waitcnt vmcnt(16)
  s_barrier
  s_cmp_lg_u32 s43, 2
  s_cbranch_scc1 L_bx_rwq_2
  s_barrier
L_bx_rwq_2:
  s_mov_b32 m0, 0
  s_nop 0
  buffer_load_dwordx4 v4, s[32:35], s40 offen lds
  s_add_u32 s40, s40, 32768
  s_add_u32 m0, m0, 1024
  s_nop 0
  buffer_load_dwordx4 v4, s[32:35], s40 offen lds
  s_add_u32 s40, s40, 32768
  s_add_u32 m0, m0, 1024
  s_nop 0
  buffer_load_dwordx4 v4, s[32:35], s40 offen lds
  s_add_u32 s40, s40, 32768
  s_add_u32 m0, m0, 1024
  s_nop 0
  buffer_load_dwordx4 v4, s[32:35], s40 offen lds
  s_add_u32 s40, s40, 32768
  s_add_u32 m0, m0, 1024
  s_nop 0
  buffer_load_dwordx4 v4, s[32:35], s40 offen lds
  s_add_u32 s40, s40, 32768
  s_add_u32 m0, m0, 1024
  s_nop 0
  buffer_load_dwordx4 v4, s[32:35], s40 offen lds
  s_add_u32 s40, s40, 32768
  s_add_u32 m0, m0, 1024
  s_nop 0
  buffer_load_dwordx4 v4, s[32:35], s40 offen lds
  s_add_u32 s40, s40, 32768
  s_add_u32 m0, m0, 1024
  s_nop 0
  buffer_load_dwordx4 v4, s[32:35], s40 offen lds
  s_add_u32 s40, s40, 32768
  s_add_u32 m0, m0, 1024
  s_nop 0
  buffer_load_dwordx4 v4, s[32:35], s40 offen lds
  s_add_u32 s40, s40, 32768
  s_add_u32 m0, m0, 1024
  s_nop 0
  buffer_load_dwordx4 v4, s[32:35], s40 offen lds
  s_add_u32 s40, s40, 32768
  s_add_u32 m0, m0, 1024
  s_nop 0
  buffer_load_dwordx4 v4, s[32:35], s40 offen lds
  s_add_u32 s40, s40, 32768
  s_add_u32 m0, m0, 1024
  s_nop 0
  buffer_load_dwordx4 v4, s[32:35], s40 offen lds
  s_add_u32 s40, s40, 32768
  s_add_u32 m0, m0, 1024
  s_nop 0
  buffer_load_dwordx4 v4, s[32:35], s40 offen lds
  s_add_u32 s40, s40, 32768
  s_add_u32 m0, m0, 1024
  s_nop 0
  buffer_load_dwordx4 v4, s[32:35], s40 offen lds
  s_add_u32 s40, s40, 32768
  s_add_u32 m0, m0, 1024
  s_nop 0
  buffer_load_dwordx4 v4, s[32:35], s40 offen lds
  s_add_u32 s40, s40, 32768
  s_add_u32 m0, m0, 1024
  s_nop 0
  buffer_load_dwordx4 v4, s[32:35], s40 offen lds
  s_add_u32 s40, s40, 32768
  s_waitcnt vmcnt(16)
  s_barrier
  s_cmp_lg_u32 s43, 3
  s_cbranch_scc1 L_bx_rwq_3
  s_barrier
L_bx_rwq_3:
  s_mov_b32 m0, 32768
  s_nop 0
  buffer_load_dwordx4 v4, s[32:35], s40 offen lds
  s_add_u32 s40, s40, 32768
  s_add_u32 m0, m0, 1024
  s_nop 0
  buffer_load_dwordx4 v4, s[32:35], s40 offen lds
  s_add_u32 s40, s40, 32768
  s_add_u32 m0, m0, 1024
  s_nop 0
  buffer_load_dwordx4 v4, s[32:35], s40 offen lds
  s_add_u32 s40, s40, 32768
  s_add_u32 m0, m0, 1024
  s_nop 0
  buffer_load_dwordx4 v4, s[32:35], s40 offen lds
  s_add_u32 s40, s40, 32768
  s_add_u32 m0, m0, 1024
  s_nop 0
  buffer_load_dwordx4 v4, s[32:35], s40 offen lds
  s_add_u32 s40, s40, 32768
  s_add_u32 m0, m0, 1024
  s_nop 0
  buffer_load_dwordx4 v4, s[32:35], s40 offen lds
  s_add_u32 s40, s40, 32768
  s_add_u32 m0, m0, 1024
  s_nop 0
  buffer_load_dwordx4 v4, s[32:35], s40 offen lds
  s_add_u32 s40, s40, 32768
  s_add_u32 m0, m0, 1024
  s_nop 0
  buffer_load_dwordx4 v4, s[32:35], s40 offen lds
  s_add_u32 s40, s40, 32768
  s_add_u32 m0, m0, 1024
  s_nop 0
  buffer_load_dwordx4 v4, s[32:35], s40 offen lds
  s_add_u32 s40, s40, 32768
  s_add_u32 m0, m0, 1024
  s_nop 0
  buffer_load_dwordx4 v4, s[32:35], s40 offen lds
  s_add_u32 s40, s40, 32768
  s_add_u32 m0, m0, 1024
  s_nop 0
  buffer_load_dwordx4 v4, s[32:35], s40 offen lds
  s_add_u32 s40, s40, 32768
  s_add_u32 m0, m0, 1024
  s_nop 0
  buffer_load_dwordx4 v4, s[32:35], s40 offen lds
  s_add_u32 s40, s40, 32768
  s_add_u32 m0, m0, 1024
  s_nop 0
  buffer_load_dwordx4 v4, s[32:35], s40 offen lds
  s_add_u32 s40, s40, 32768
  s_add_u32 m0, m0, 1024
  s_nop 0
  buffer_load_dwordx4 v4, s[32:35], s40 offen lds
  s_add_u32 s40, s40, 32768
  s_add_u32 m0, m0, 1024
  s_nop 0
  buffer_load_dwordx4 v4, s[32:35], s40 offen lds
  s_add_u32 s40, s40, 32768
  s_add_u32 m0, m0, 1024
  s_nop 0
  buffer_load_dwordx4 v4, s[32:35], s40 offen lds
  s_add_u32 s40, s40, 32768
  s_waitcnt vmcnt(16)
  s_barrier
  s_cmp_lg_u32 s43, 4
  s_cbranch_scc1 L_bx_rwq_4
  s_barrier
L_bx_rwq_4:
  s_mov_b32 m0, 65536
  s_nop 0
  buffer_load_dwordx4 v4, s[32:35], s40 offen lds
  s_add_u32 s40, s40, 32768
  s_add_u32 m0, m0, 1024
  s_nop 0
  buffer_load_dwordx4 v4, s[32:35], s40 offen lds
  s_add_u32 s40, s40, 32768
  s_add_u32 m0, m0, 1024
  s_nop 0
  buffer_load_dwordx4 v4, s[32:35], s40 offen lds
  s_add_u32 s40, s40, 32768
  s_add_u32 m0, m0, 1024
  s_nop 0
  buffer_load_dwordx4 v4, s[32:35], s40 offen lds
  s_add_u32 s40, s40, 32768
  s_add_u32 m0, m0, 1024
  s_nop 0
  buffer_load_dwordx4 v4, s[32:35], s40 offen lds
  s_add_u32 s40, s40, 32768
  s_add_u32 m0, m0, 1024
  s_nop 0
  buffer_load_dwordx4 v4, s[32:35], s40 offen lds
  s_add_u32 s40, s40, 32768
  s_add_u32 m0, m0, 1024
  s_nop 0
  buffer_load_dwordx4 v4, s[32:35], s40 offen lds
  s_add_u32 s40, s40, 32768
  s_add_u32 m0, m0, 1024
  s_nop 0
  buffer_load_dwordx4 v4, s[32:35], s40 offen lds
  s_add_u32 s40, s40, 32768
  s_add_u32 m0, m0, 1024
  s_nop 0
  buffer_load_dwordx4 v4, s[32:35], s40 offen lds
  s_add_u32 s40, s40, 32768
  s_add_u32 m0, m0, 1024
  s_nop 0
  buffer_load_dwordx4 v4, s[32:35], s40 offen lds
  s_add_u32 s40, s40, 32768
  s_add_u32 m0, m0, 1024
  s_nop 0
  buffer_load_dwordx4 v4, s[32:35], s40 offen lds
  s_add_u32 s40, s40, 32768
  s_add_u32 m0, m0, 1024
  s_nop 0
  buffer_load_dwordx4 v4, s[32:35], s40 offen lds
  s_add_u32 s40, s40, 32768
  s_add_u32 m0, m0, 1024
  s_nop 0
  buffer_load_dwordx4 v4, s[32:35], s40 offen lds
  s_add_u32 s40, s40, 32768
  s_add_u32 m0, m0, 1024
  s_nop 0
  buffer_load_dwordx4 v4, s[32:35], s40 offen lds
  s_add_u32 s40, s40, 32768
  s_add_u32 m0, m0, 1024
  s_nop 0
  buffer_load_dwordx4 v4, s[32:35], s40 offen lds
  s_add_u32 s40, s40, 32768
  s_add_u32 m0, m0, 1024
  s_nop 0
  buffer_load_dwordx4 v4, s[32:35], s40 offen lds
  s_add_u32 s40, s40, 32768
  s_waitcnt vmcnt(16)
  s_barrier
  s_cmp_lg_u32 s43, 5
  s_cbranch_scc1 L_bx_rwq_5
  s_barrier
L_bx_rwq_5:
  s_mov_b32 m0, 0
  s_nop 0
  buffer_load_dwordx4 v4, s[32:35], s40 offen lds
  s_add_u32 s40, s40, 32768
  s_add_u32 m0, m0, 1024
  s_nop 0
  buffer_load_dwordx4 v4, s[32:35], s40 offen lds
  s_add_u32 s40, s40, 32768
  s_add_u32 m0, m0, 1024
  s_nop 0
  buffer_load_dwordx4 v4, s[32:35], s40 offen lds
  s_add_u32 s40, s40, 32768
  s_add_u32 m0, m0, 1024
  s_nop 0
  buffer_load_dwordx4 v4, s[32:35], s40 offen lds
  s_add_u32 s40, s40, 32768
  s_add_u32 m0, m0, 1024
  s_nop 0
  buffer_load_dwordx4 v4, s[32:35], s40 offen lds
  s_add_u32 s40, s40, 32768
  s_add_u32 m0, m0, 1024
  s_nop 0
  buffer_load_dwordx4 v4, s[32:35], s40 offen lds
  s_add_u32 s40, s40, 32768
  s_add_u32 m0, m0, 1024
  s_nop 0
  buffer_load_dwordx4 v4, s[32:35], s40 offen lds
  s_add_u32 s40, s40, 32768
  s_add_u32 m0, m0, 1024
  s_nop 0
  buffer_load_dwordx4 v4, s[32:35], s40 offen lds
  s_add_u32 s40, s40, 32768
  s_add_u32 m0, m0, 1024
  s_nop 0
  buffer_load_dwordx4 v4, s[32:35], s40 offen lds
  s_add_u32 s40, s40, 32768
  s_add_u32 m0, m0, 1024
  s_nop 0
  buffer_load_dwordx4 v4, s[32:35], s40 offen lds
  s_add_u32 s40, s40, 32768
  s_add_u32 m0, m0, 1024
  s_nop 0
  buffer_load_dwordx4 v4, s[32:35], s40 offen lds
  s_add_u32 s40, s40, 32768
  s_add_u32 m0, m0, 1024
  s_nop 0
  buffer_load_dwordx4 v4, s[32:35], s40 offen lds
  s_add_u32 s40, s40, 32768
  s_add_u32 m0, m0, 1024
  s_nop 0
  buffer_load_dwordx4 v4, s[32:35], s40 offen lds
  s_add_u32 s40, s40, 32768
  s_add_u32 m0, m0, 1024
  s_nop 0
  buffer_load_dwordx4 v4, s[32:35], s40 offen lds
  s_add_u32 s40, s40, 32768
  s_add_u32 m0, m0, 1024
  s_nop 0
  buffer_load_dwordx4 v4, s[32:35], s40 offen lds
  s_add_u32 s40, s40, 32768
  s_add_u32 m0, m0, 1024
  s_nop 0
  buffer_load_dwordx4 v4, s[32:35], s40 offen lds
  s_add_u32 s40, s40, 32768
  s_waitcnt vmcnt(16)
  s_barrier
  s_cmp_lg_u32 s43, 6
  s_cbranch_scc1 L_bx_rwq_6
  s_barrier
L_bx_rwq_6:
  s_mov_b32 m0, 32768
  s_nop 0
  buffer_load_dwordx4 v4, s[32:35], s40 offen lds
  s_add_u32 s40, s40, 32768
  s_add_u32 m0, m0, 1024
  s_nop 0
  buffer_load_dwordx4 v4, s[32:35], s40 offen lds
  s_add_u32 s40, s40, 32768
  s_add_u32 m0, m0, 1024
  s_nop 0
  buffer_load_dwordx4 v4, s[32:35], s40 offen lds
  s_add_u32 s40, s40, 32768
  s_add_u32 m0, m0, 1024
  s_nop 0
  buffer_load_dwordx4 v4, s[32:35], s40 offen lds
  s_add_u32 s40, s40, 32768
  s_add_u32 m0, m0, 1024
  s_nop 0
  buffer_load_dwordx4 v4, s[32:35], s40 offen lds
  s_add_u32 s40, s40, 32768
  s_add_u32 m0, m0, 1024
  s_nop 0
  buffer_load_dwordx4 v4, s[32:35], s40 offen lds
  s_add_u32 s40, s40, 32768
  s_add_u32 m0, m0, 1024
  s_nop 0
  buffer_load_dwordx4 v4, s[32:35], s40 offen lds
  s_add_u32 s40, s40, 32768
  s_add_u32 m0, m0, 1024
  s_nop 0
  buffer_load_dwordx4 v4, s[32:35], s40 offen lds
  s_add_u32 s40, s40, 32768
  s_add_u32 m0, m0, 1024
  s_nop 0
  buffer_load_dwordx4 v4, s[32:35], s40 offen lds
  s_add_u32 s40, s40, 32768
  s_add_u32 m0, m0, 1024
  s_nop 0
  buffer_load_dwordx4 v4, s[32:35], s40 offen lds
  s_add_u32 s40, s40, 32768
  s_add_u32 m0, m0, 1024
  s_nop 0
  buffer_load_dwordx4 v4, s[32:35], s40 offen lds
  s_add_u32 s40, s40, 32768
  s_add_u32 m0, m0, 1024
  s_nop 0
  buffer_load_dwordx4 v4, s[32:35], s40 offen lds
  s_add_u32 s40, s40, 32768
  s_add_u32 m0, m0, 1024
  s_nop 0
  buffer_load_dwordx4 v4, s[32:35], s40 offen lds
  s_add_u32 s40, s40, 32768
  s_add_u32 m0, m0, 1024
  s_nop 0
  buffer_load_dwordx4 v4, s[32:35], s40 offen lds
  s_add_u32 s40, s40, 32768
  s_add_u32 m0, m0, 1024
  s_nop 0
  buffer_load_dwordx4 v4, s[32:35], s40 offen lds
  s_add_u32 s40, s40, 32768
  s_add_u32 m0, m0, 1024
  s_nop 0
  buffer_load_dwordx4 v4, s[32:35], s40 offen lds
  s_add_u32 s40, s40, 32768
  s_waitcnt vmcnt(16)
  s_barrier
  s_mov_b32 m0, 65536
  s_nop 0
  buffer_load_dwordx4 v4, s[32:35], s40 offen lds
  s_add_u32 s40, s40, 32768
  s_add_u32 m0, m0, 1024
  s_nop 0
  buffer_load_dwordx4 v4, s[32:35], s40 offen lds
  s_add_u32 s40, s40, 32768
  s_add_u32 m0, m0, 1024
  s_nop 0
  buffer_load_dwordx4 v4, s[32:35], s40 offen lds
  s_add_u32 s40, s40, 32768
  s_add_u32 m0, m0, 1024
  s_nop 0
  buffer_load_dwordx4 v4, s[32:35], s40 offen lds
  s_add_u32 s40, s40, 32768
  s_add_u32 m0, m0, 1024
  s_nop 0
  buffer_load_dwordx4 v4, s[32:35], s40 offen lds
  s_add_u32 s40, s40, 32768
  s_add_u32 m0, m0, 1024
  s_nop 0
  buffer_load_dwordx4 v4, s[32:35], s40 offen lds
  s_add_u32 s40, s40, 32768
  s_add_u32 m0, m0, 1024
  s_nop 0
  buffer_load_dwordx4 v4, s[32:35], s40 offen lds
  s_add_u32 s40, s40, 32768
  s_add_u32 m0, m0, 1024
  s_nop 0
  buffer_load_dwordx4 v4, s[32:35], s40 offen lds
  s_add_u32 s40, s40, 32768
  s_add_u32 m0, m0, 1024
  s_nop 0
  buffer_load_dwordx4 v4, s[32:35], s40 offen lds
  s_add_u32 s40, s40, 32768
  s_add_u32 m0, m0, 1024
  s_nop 0
  buffer_load_dwordx4 v4, s[32:35], s40 offen lds
  s_add_u32 s40, s40, 32768
  s_add_u32 m0, m0, 1024
  s_nop 0
  buffer_load_dwordx4 v4, s[32:35], s40 offen lds
  s_add_u32 s40, s40, 32768
  s_add_u32 m0, m0, 1024
  s_nop 0
  buffer_load_dwordx4 v4, s[32:35], s40 offen lds
  s_add_u32 s40, s40, 32768
  s_add_u32 m0, m0, 1024
  s_nop 0
  buffer_load_dwordx4 v4, s[32:35], s40 offen lds
  s_add_u32 s40, s40, 32768
  s_add_u32 m0, m0, 1024
  s_nop 0
  buffer_load_dwordx4 v4, s[32:35], s40 offen lds
  s_add_u32 s40, s40, 32768
  s_add_u32 m0, m0, 1024
  s_nop 0
  buffer_load_dwordx4 v4, s[32:35], s40 offen lds
  s_add_u32 s40, s40, 32768
  s_add_u32 m0, m0, 1024
  s_nop 0
  buffer_load_dwordx4 v4, s[32:35], s40 offen lds
  s_add_u32 s40, s40, 32768
  s_waitcnt vmcnt(16)
  s_barrier
  s_mov_b32 s52, s24
  s_and_b32 s53, s25, 0xffff
  s_mov_b32 s54, 4718592
  s_mov_b32 s55, 0x00020000
  v_add_u32 v1, 0, v0
  v_mul_u32_u24 v2, 3641, v1
  v_lshrrev_b32 v2, 16, v2
  v_mul_u32_u24 v3, 18, v2
  v_sub_u32 v3, v1, v3
  v_lshlrev_b32 v3, 4, v3
  v_mul_u32_u24 v2, 1152, v2
  v_add_u32 v16, v2, v3
  v_add_u32 v1, 64, v0
  v_mul_u32_u24 v2, 3641, v1
  v_lshrrev_b32 v2, 16, v2
  v_mul_u32_u24 v3, 18, v2
  v_sub_u32 v3, v1, v3
  v_lshlrev_b32 v3, 4, v3
  v_mul_u32_u24 v2, 1152, v2
  v_add_u32 v17, v2, v3
  v_add_u32 v1, 128, v0
  v_mul_u32_u24 v2, 3641, v1
  v_lshrrev_b32 v2, 16, v2
  v_mul_u32_u24 v3, 18, v2
  v_sub_u32 v3, v1, v3
  v_lshlrev_b32 v3, 4, v3
  v_mul_u32_u24 v2, 1152, v2
  v_add_u32 v18, v2, v3
  v_add_u32 v1, 192, v0
  v_mul_u32_u24 v2, 3641, v1
  v_lshrrev_b32 v2, 16, v2
  v_mul_u32_u24 v3, 18, v2
  v_sub_u32 v3, v1, v3
  v_lshlrev_b32 v3, 4, v3
  v_mul_u32_u24 v2, 1152, v2
  v_add_u32 v19, v2, v3
  v_add_u32 v1, 256, v0
  v_mul_u32_u24 v2, 3641, v1
  v_lshrrev_b32 v2, 16, v2
  v_mul_u32_u24 v3, 18, v2
  v_sub_u32 v3, v1, v3
  v_lshlrev_b32 v3, 4, v3
  v_mul_u32_u24 v2, 1152, v2
  v_add_u32 v20, v2, v3
  v_add_u32 v1, 320, v0
  v_mul_u32_u24 v2, 3641, v1
  v_lshrrev_b32 v2, 16, v2
  v_mul_u32_u24 v3, 18, v2
  v_sub_u32 v3, v1, v3
  v_lshlrev_b32 v3, 4, v3
  v_mul_u32_u24 v2, 1152, v2
  v_add_u32 v21, v2, v3
  v_add_u32 v1, 384, v0
  v_mul_u32_u24 v2, 3641, v1
  v_lshrrev_b32 v2, 16, v2
  v_mul_u32_u24 v3, 18, v2
  v_sub_u32 v3, v1, v3
  v_lshlrev_b32 v3, 4, v3
  v_mul_u32_u24 v2, 1152, v2
  v_add_u32 v22, v2, v3
  v_add_u32 v1, 448, v0
  v_mul_u32_u24 v2, 3641, v1
  v_lshrrev_b32 v2, 16, v2
  v_mul_u32_u24 v3, 18, v2
  v_sub_u32 v3, v1, v3
  v_lshlrev_b32 v3, 4, v3
  v_mul_u32_u24 v2, 1152, v2
  v_add_u32 v23, v2, v3
  v_add_u32 v1, 512, v0
  v_mul_u32_u24 v2, 3641, v1
  v_lshrrev_b32 v2, 16, v2
  v_mul_u32_u24 v3, 18, v2
  v_sub_u32 v3, v1, v3
  v_lshlrev_b32 v3, 4, v3
  v_mul_u32_u24 v2, 1152, v2
  v_add_u32 v24, v2, v3
  s_mul_i32 s56, s6, 288
  s_waitcnt vmcnt(0)
  s_barrier
  s_barrier
  s_add_u32 s57, s6, 0
  s_and_b32 s57, s57, 3
  s_lshl_b32 s58, s4, 2
  s_add_u32 s57, s57, s58
  s_mul_i32 s57, s57, 147456
  s_add_u32 s57, s57, s56
  s_mov_b32 m0, 0
  s_nop 0
  buffer_load_dwordx4 v16, s[52:55], s57 offen lds
  s_add_u32 m0, m0, 1024
  s_nop 0
  buffer_load_dwordx4 v17, s[52:55], s57 offen lds
  s_add_u32 m0, m0, 1024
  s_nop 0
  buffer_load_dwordx4 v18, s[52:55], s57 offen lds
  s_add_u32 m0, m0, 1024
  s_nop 0
  buffer_load_dwordx4 v19, s[52:55], s57 offen lds
  s_add_u32 m0, m0, 1024
  s_nop 0
  buffer_load_dwordx4 v20, s[52:55], s57 offen lds
  s_add_u32 m0, m0, 1024
  s_nop 0
  buffer_load_dwordx4 v21, s[52:55], s57 offen lds
  s_add_u32 m0, m0, 1024
  s_nop 0
  buffer_load_dwordx4 v22, s[52:55], s57 offen lds
  s_add_u32 m0, m0, 1024
  s_nop 0
  buffer_load_dwordx4 v23, s[52:55], s57 offen lds
  s_add_u32 m0, m0, 1024
  s_nop 0
  buffer_load_dwordx4 v24, s[52:55], s57 offen lds
  s_add_u32 m0, m0, 1024
  s_add_u32 s57, s57, 36864
  buffer_load_dwordx4 v16, s[52:55], s57 offen lds
  s_add_u32 m0, m0, 1024
  s_nop 0
  buffer_load_dwordx4 v17, s[52:55], s57 offen lds
  s_add_u32 m0, m0, 1024
  s_nop 0
  buffer_load_dwordx4 v18, s[52:55], s57 offen lds
  s_add_u32 m0, m0, 1024
  s_nop 0
  buffer_load_dwordx4 v19, s[52:55], s57 offen lds
  s_add_u32 m0, m0, 1024
  s_nop 0
  buffer_load_dwordx4 v20, s[52:55], s57 offen lds
  s_add_u32 m0, m0, 1024
  s_nop 0
  buffer_load_dwordx4 v21, s[52:55], s57 offen lds
  s_add_u32 m0, m0, 1024
  s_nop 0
  buffer_load_dwordx4 v22, s[52:55], s57 offen lds
  s_add_u32 m0, m0, 1024
  s_nop 0
  buffer_load_dwordx4 v23, s[52:55], s57 offen lds
  s_add_u32 m0, m0, 1024
  s_nop 0
  buffer_load_dwordx4 v24, s[52:55], s57 offen lds
  s_add_u32 s57, s6, 1
  s_and_b32 s57, s57, 3
  s_lshl_b32 s58, s4, 2
  s_add_u32 s57, s57, s58
  s_mul_i32 s57, s57, 147456
  s_add_u32 s57, s57, s56
  s_mov_b32 m0, 36864
  s_nop 0
  buffer_load_dwordx4 v16, s[52:55], s57 offen lds
  s_add_u32 m0, m0, 1024
  s_nop 0
  buffer_load_dwordx4 v17, s[52:55], s57 offen lds
  s_add_u32 m0, m0, 1024
  s_nop 0
  buffer_load_dwordx4 v18, s[52:55], s57 offen lds
  s_add_u32 m0, m0, 1024
  s_nop 0
  buffer_load_dwordx4 v19, s[52:55], s57 offen lds
  s_add_u32 m0, m0, 1024
  s_nop 0
  buffer_load_dwordx4 v20, s[52:55], s57 offen lds
  s_add_u32 m0, m0, 1024
  s_nop 0
  buffer_load_dwordx4 v21, s[52:55], s57 offen lds
  s_add_u32 m0, m0, 1024
  s_nop 0
  buffer_load_dwordx4 v22, s[52:55], s57 offen lds
  s_add_u32 m0, m0, 1024
  s_nop 0
  buffer_load_dwordx4 v23, s[52:55], s57 offen lds
  s_add_u32 m0, m0, 1024
  s_nop 0
  buffer_load_dwordx4 v24, s[52:55], s57 offen lds
  s_add_u32 m0, m0, 1024
  s_add_u32 s57, s57, 36864
  buffer_load_dwordx4 v16, s[52:55], s57 offen lds
  s_add_u32 m0, m0, 1024
  s_nop 0
  buffer_load_dwordx4 v17, s[52:55], s57 offen lds
  s_add_u32 m0, m0, 1024
  s_nop 0
  buffer_load_dwordx4 v18, s[52:55], s57 offen lds
  s_add_u32 m0, m0, 1024
  s_nop 0
  buffer_load_dwordx4 v19, s[52:55], s57 offen lds
  s_add_u32 m0, m0, 1024
  s_nop 0
  buffer_load_dwordx4 v20, s[52:55], s57 offen lds
  s_add_u32 m0, m0, 1024
  s_nop 0
  buffer_load_dwordx4 v21, s[52:55], s57 offen lds
  s_add_u32 m0, m0, 1024
  s_nop 0
  buffer_load_dwordx4 v22, s[52:55], s57 offen lds
  s_add_u32 m0, m0, 1024
  s_nop 0
  buffer_load_dwordx4 v23, s[52:55], s57 offen lds
  s_add_u32 m0, m0, 1024
  s_nop 0
  buffer_load_dwordx4 v24, s[52:55], s57 offen lds
  s_waitcnt vmcnt(18)
  s_barrier
  s_add_u32 s57, s6, 2
  s_and_b32 s57, s57, 3
  s_lshl_b32 s58, s4, 2
  s_add_u32 s57, s57, s58
  s_mul_i32 s57, s57, 147456
  s_add_u32 s57, s57, s56
  s_mov_b32 m0, 73728
  s_nop 0
  buffer_load_dwordx4 v16, s[52:55], s57 offen lds
  s_add_u32 m0, m0, 1024
  s_nop 0
  buffer_load_dwordx4 v17, s[52:55], s57 offen lds
  s_add_u32 m0, m0, 1024
  s_nop 0
  buffer_load_dwordx4 v18, s[52:55], s57 offen lds
  s_add_u32 m0, m0, 1024
  s_nop 0
  buffer_load_dwordx4 v19, s[52:55], s57 offen lds
  s_add_u32 m0, m0, 1024
  s_nop 0
  buffer_load_dwordx4 v20, s[52:55], s57 offen lds
  s_add_u32 m0, m0, 1024
  s_nop 0
  buffer_load_dwordx4 v21, s[52:55], s57 offen lds
  s_add_u32 m0, m0, 1024
  s_nop 0
  buffer_load_dwordx4 v22, s[52:55], s57 offen lds
  s_add_u32 m0, m0, 1024
  s_nop 0
  buffer_load_dwordx4 v23, s[52:55], s57 offen lds
  s_add_u32 m0, m0, 1024
  s_nop 0
  buffer_load_dwordx4 v24, s[52:55], s57 offen lds
  s_add_u32 s57, s6, 3
  s_and_b32 s57, s57, 3
  s_lshl_b32 s58, s4, 2
  s_add_u32 s57, s57, s58
  s_mul_i32 s57, s57, 147456
  s_add_u32 s57, s57, s56
  s_mov_b32 m0, 110592
  s_nop 0
  buffer_load_dwordx4 v16, s[52:55], s57 offen lds
  s_add_u32 m0, m0, 1024
  s_nop 0
  buffer_load_dwordx4 v17, s[52:55], s57 offen lds
  s_add_u32 m0, m0, 1024
  s_nop 0
  buffer_load_dwordx4 v18, s[52:55], s57 offen lds
  s_add_u32 m0, m0, 1024
  s_nop 0
  buffer_load_dwordx4 v19, s[52:55], s57 offen lds
  s_add_u32 m0, m0, 1024
  s_nop 0
  buffer_load_dwordx4 v20, s[52:55], s57 offen lds
  s_add_u32 m0, m0, 1024
  s_nop 0
  buffer_load_dwordx4 v21, s[52:55], s57 offen lds
  s_add_u32 m0, m0, 1024
  s_nop 0
  buffer_load_dwordx4 v22, s[52:55], s57 offen lds
  s_add_u32 m0, m0, 1024
  s_nop 0
  buffer_load_dwordx4 v23, s[52:55], s57 offen lds
  s_add_u32 m0, m0, 1024
  s_nop 0
  buffer_load_dwordx4 v24, s[52:55], s57 offen lds
  s_waitcnt vmcnt(18)
  s_barrier
  s_waitcnt vmcnt(9)
  s_barrier
  s_waitcnt vmcnt(0)
  s_barrier
  s_endpgm
L_a_ldx:
  v_lshrrev_b32 v1, 3, v0
  v_mul_u32_u24 v1, 1152, v1
  v_and_b32 v2, 7, v0
  v_lshrrev_b32 v3, 4, v0
  v_xor_b32 v2, v2, v3
  v_lshlrev_b32 v4, 4, v2
  v_add_u32 v4, v4, v1
  v_xor_b32 v2, 4, v2
  v_lshlrev_b32 v5, 4, v2
  v_add_u32 v5, v5, v1
  s_mul_i32 s41, s9, 147456
  s_and_b32 s43, s9, 3
  s_lshl_b32 s43, s43, 2
  s_lshr_b32 s43, 30000, s43
  s_and_b32 s43, s43, 15
  v_mul_u32_u24 v8, 7282, v0
  v_lshrrev_b32 v8, 16, v8
  v_mul_u32_u24 v9, 9, v8
  v_sub_u32 v9, v0, v9
  v_mul_u32_u24 v8, 1152, v8
  v_lshl_add_u32 v8, v9, 7, v8
  s_mul_i32 s46, s9, 147456
  s_mul_i32 s47, s10, 4608
  s_add_u32 s46, s46, s47
  s_waitcnt lgkmcnt(0)
  s_mov_b32 s32, s16
  s_and_b32 s33, s17, 0xffff
  s_mov_b32 s34, 1179648
  s_mov_b32 s35, 0x00020000
  s_mov_b32 exec_lo, -1
  s_mov_b32 exec_hi, 15
  buffer_load_dword v10, v8, s[32:35], s46 offen
  s_mov_b64 exec, -1
  s_mov_b32 m0, 16384
  s_add_u32 s40, s41, 0
  buffer_load_dwordx4 v4, s[32:35], s40 offen lds
  s_add_u32 m0, m0, 1024
  s_add_u32 s40, s40, 9216
  buffer_load_dwordx4 v5, s[32:35], s40 offen lds
  s_add_u32 m0, m0, 1024
  s_add_u32 s40, s40, 9216
  buffer_load_dwordx4 v4, s[32:35], s40 offen lds
  s_add_u32 m0, m0, 1024
  s_add_u32 s40, s40, 9216
  buffer_load_dwordx4 v5, s[32:35], s40 offen lds
  s_add_u32 m0, m0, 1024
  s_add_u32 s40, s40, 9216
  buffer_load_dwordx4 v4, s[32:35], s40 offen lds
  s_add_u32 m0, m0, 1024
  s_add_u32 s40, s40, 9216
  buffer_load_dwordx4 v5, s[32:35], s40 offen lds
  s_add_u32 m0, m0, 1024
  s_add_u32 s40, s40, 9216
  buffer_load_dwordx4 v4, s[32:35], s40 offen lds
  s_add_u32 m0, m0, 1024
  s_add_u32 s40, s40, 9216
  buffer_load_dwordx4 v5, s[32:35], s40 offen lds
  s_add_u32 m0, m0, 1024
  s_add_u32 s40, s40, 9216
  buffer_load_dwordx4 v4, s[32:35], s40 offen lds
  s_add_u32 m0, m0, 1024
  s_add_u32 s40, s40, 9216
  buffer_load_dwordx4 v5, s[32:35], s40 offen lds
  s_add_u32 m0, m0, 1024
  s_add_u32 s40, s40, 9216
  buffer_load_dwordx4 v4, s[32:35], s40 offen lds
  s_add_u32 m0, m0, 1024
  s_add_u32 s40, s40, 9216
  buffer_load_dwordx4 v5, s[32:35], s40 offen lds
  s_add_u32 m0, m0, 1024
  s_add_u32 s40, s40, 9216
  buffer_load_dwordx4 v4, s[32:35], s40 offen lds
  s_add_u32 m0, m0, 1024
  s_add_u32 s40, s40, 9216
  buffer_load_dwordx4 v5, s[32:35], s40 offen lds
  s_add_u32 m0, m0, 1024
  s_add_u32 s40, s40, 9216
  buffer_load_dwordx4 v4, s[32:35], s40 offen lds
  s_add_u32 m0, m0, 1024
  s_add_u32 s40, s40, 9216
  buffer_load_dwordx4 v5, s[32:35], s40 offen lds
  s_barrier
  s_cmp_lg_u32 s43, 0
  s_cbranch_scc1 L_bx_rx_0
  s_barrier
L_bx_rx_0:
  s_mov_b32 m0, 49152
  s_add_u32 s40, s41, 128
  buffer_load_dwordx4 v4, s[32:35], s40 offen lds
  s_add_u32 m0, m0, 1024
  s_add_u32 s40, s40, 9216
  buffer_load_dwordx4 v5, s[32:35], s40 offen lds
  s_add_u32 m0, m0, 1024
  s_add_u32 s40, s40, 9216
  buffer_load_dwordx4 v4, s[32:35], s40 offen lds
  s_add_u32 m0, m0, 1024
  s_add_u32 s40, s40, 9216
  buffer_load_dwordx4 v5, s[32:35], s40 offen lds
  s_add_u32 m0, m0, 1024
  s_add_u32 s40, s40, 9216
  buffer_load_dwordx4 v4, s[32:35], s40 offen lds
  s_add_u32 m0, m0, 1024
  s_add_u32 s40, s40, 9216
  buffer_load_dwordx4 v5, s[32:35], s40 offen lds
  s_add_u32 m0, m0, 1024
  s_add_u32 s40, s40, 9216
  buffer_load_dwordx4 v4, s[32:35], s40 offen lds
  s_add_u32 m0, m0, 1024
  s_add_u32 s40, s40, 9216
  buffer_load_dwordx4 v5, s[32:35], s40 offen lds
  s_add_u32 m0, m0, 1024
  s_add_u32 s40, s40, 9216
  buffer_load_dwordx4 v4, s[32:35], s40 offen lds
  s_add_u32 m0, m0, 1024
  s_add_u32 s40, s40, 9216
  buffer_load_dwordx4 v5, s[32:35], s40 offen lds
  s_add_u32 m0, m0, 1024
  s_add_u32 s40, s40, 9216
  buffer_load_dwordx4 v4, s[32:35], s40 offen lds
  s_add_u32 m0, m0, 1024
  s_add_u32 s40, s40, 9216
  buffer_load_dwordx4 v5, s[32:35], s40 offen lds
  s_add_u32 m0, m0, 1024
  s_add_u32 s40, s40, 9216
  buffer_load_dwordx4 v4, s[32:35], s40 offen lds
  s_add_u32 m0, m0, 1024
  s_add_u32 s40, s40, 9216
  buffer_load_dwordx4 v5, s[32:35], s40 offen lds
  s_add_u32 m0, m0, 1024
  s_add_u32 s40, s40, 9216
  buffer_load_dwordx4 v4, s[32:35], s40 offen lds
  s_add_u32 m0, m0, 1024
  s_add_u32 s40, s40, 9216
  buffer_load_dwordx4 v5, s[32:35], s40 offen lds
  s_waitcnt vmcnt(16)
  s_barrier
  s_cmp_lg_u32 s43, 1
  s_cbranch_scc1 L_bx_rx_1
  s_barrier
L_bx_rx_1:
  s_mov_b32 m0, 81920
  s_add_u32 s40, s41, 256
  buffer_load_dwordx4 v4, s[32:35], s40 offen lds
  s_add_u32 m0, m0, 1024
  s_add_u32 s40, s40, 9216
  buffer_load_dwordx4 v5, s[32:35], s40 offen lds
  s_add_u32 m0, m0, 1024
  s_add_u32 s40, s40, 9216
  buffer_load_dwordx4 v4, s[32:35], s40 offen lds
  s_add_u32 m0, m0, 1024
  s_add_u32 s40, s40, 9216
  buffer_load_dwordx4 v5, s[32:35], s40 offen lds
  s_add_u32 m0, m0, 1024
  s_add_u32 s40, s40, 9216
  buffer_load_dwordx4 v4, s[32:35], s40 offen lds
  s_add_u32 m0, m0, 1024
  s_add_u32 s40, s40, 9216
  buffer_load_dwordx4 v5, s[32:35], s40 offen lds
  s_add_u32 m0, m0, 1024
  s_add_u32 s40, s40, 9216
  buffer_load_dwordx4 v4, s[32:35], s40 offen lds
  s_add_u32 m0, m0, 1024
  s_add_u32 s40, s40, 9216
  buffer_load_dwordx4 v5, s[32:35], s40 offen lds
  s_add_u32 m0, m0, 1024
  s_add_u32 s40, s40, 9216
  buffer_load_dwordx4 v4, s[32:35], s40 offen lds
  s_add_u32 m0, m0, 1024
  s_add_u32 s40, s40, 9216
  buffer_load_dwordx4 v5, s[32:35], s40 offen lds
  s_add_u32 m0, m0, 1024
  s_add_u32 s40, s40, 9216
  buffer_load_dwordx4 v4, s[32:35], s40 offen lds
  s_add_u32 m0, m0, 1024
  s_add_u32 s40, s40, 9216
  buffer_load_dwordx4 v5, s[32:35], s40 offen lds
  s_add_u32 m0, m0, 1024
  s_add_u32 s40, s40, 9216
  buffer_load_dwordx4 v4, s[32:35], s40 offen lds
  s_add_u32 m0, m0, 1024
  s_add_u32 s40, s40, 9216
  buffer_load_dwordx4 v5, s[32:35], s40 offen lds
  s_add_u32 m0, m0, 1024
  s_add_u32 s40, s40, 9216
  buffer_load_dwordx4 v4, s[32:35], s40 offen lds
  s_add_u32 m0, m0, 1024
  s_add_u32 s40, s40, 9216
  buffer_load_dwordx4 v5, s[32:35], s40 offen lds
  s_waitcnt vmcnt(16)
  s_barrier
  s_cmp_lg_u32 s43, 2
  s_cbranch_scc1 L_bx_rx_2
  s_barrier
L_bx_rx_2:
  s_mov_b32 m0, 16384
  s_add_u32 s40, s41, 384
  buffer_load_dwordx4 v4, s[32:35], s40 offen lds
  s_add_u32 m0, m0, 1024
  s_add_u32 s40, s40, 9216
  buffer_load_dwordx4 v5, s[32:35], s40 offen lds
  s_add_u32 m0, m0, 1024
  s_add_u32 s40, s40, 9216
  buffer_load_dwordx4 v4, s[32:35], s40 offen lds
  s_add_u32 m0, m0, 1024
  s_add_u32 s40, s40, 9216
  buffer_load_dwordx4 v5, s[32:35], s40 offen lds
  s_add_u32 m0, m0, 1024
  s_add_u32 s40, s40, 9216
  buffer_load_dwordx4 v4, s[32:35], s40 offen lds
  s_add_u32 m0, m0, 1024
  s_add_u32 s40, s40, 9216
  buffer_load_dwordx4 v5, s[32:35], s40 offen lds
  s_add_u32 m0, m0, 1024
  s_add_u32 s40, s40, 9216
  buffer_load_dwordx4 v4, s[32:35], s40 offen lds
  s_add_u32 m0, m0, 1024
  s_add_u32 s40, s40, 9216
  buffer_load_dwordx4 v5, s[32:35], s40 offen lds
  s_add_u32 m0, m0, 1024
  s_add_u32 s40, s40, 9216
  buffer_load_dwordx4 v4, s[32:35], s40 offen lds
  s_add_u32 m0, m0, 1024
  s_add_u32 s40, s40, 9216
  buffer_load_dwordx4 v5, s[32:35], s40 offen lds
  s_add_u32 m0, m0, 1024
  s_add_u32 s40, s40, 9216
  buffer_load_dwordx4 v4, s[32:35], s40 offen lds
  s_add_u32 m0, m0, 1024
  s_add_u32 s40, s40, 9216
  buffer_load_dwordx4 v5, s[32:35], s40 offen lds
  s_add_u32 m0, m0, 1024
  s_add_u32 s40, s40, 9216
  buffer_load_dwordx4 v4, s[32:35], s40 offen lds
  s_add_u32 m0, m0, 1024
  s_add_u32 s40, s40, 9216
  buffer_load_dwordx4 v5, s[32:35], s40 offen lds
  s_add_u32 m0, m0, 1024
  s_add_u32 s40, s40, 9216
  buffer_load_dwordx4 v4, s[32:35], s40 offen lds
  s_add_u32 m0, m0, 1024
  s_add_u32 s40, s40, 9216
  buffer_load_dwordx4 v5, s[32:35], s40 offen lds
  s_waitcnt vmcnt(16)
  s_barrier
  s_cmp_lg_u32 s43, 3
  s_cbranch_scc1 L_bx_rx_3
  s_barrier
L_bx_rx_3:
  s_mov_b32 m0, 49152
  s_add_u32 s40, s41, 512
  buffer_load_dwordx4 v4, s[32:35], s40 offen lds
  s_add_u32 m0, m0, 1024
  s_add_u32 s40, s40, 9216
  buffer_load_dwordx4 v5, s[32:35], s40 offen lds
  s_add_u32 m0, m0, 1024
  s_add_u32 s40, s40, 9216
  buffer_load_dwordx4 v4, s[32:35], s40 offen lds
  s_add_u32 m0, m0, 1024
  s_add_u32 s40, s40, 9216
  buffer_load_dwordx4 v5, s[32:35], s40 offen lds
  s_add_u32 m0, m0, 1024
  s_add_u32 s40, s40, 9216
  buffer_load_dwordx4 v4, s[32:35], s40 offen lds
  s_add_u32 m0, m0, 1024
  s_add_u32 s40, s40, 9216
  buffer_load_dwordx4 v5, s[32:35], s40 offen lds
  s_add_u32 m0, m0, 1024
  s_add_u32 s40, s40, 9216
  buffer_load_dwordx4 v4, s[32:35], s40 offen lds
  s_add_u32 m0, m0, 1024
  s_add_u32 s40, s40, 9216
  buffer_load_dwordx4 v5, s[32:35], s40 offen lds
  s_add_u32 m0, m0, 1024
  s_add_u32 s40, s40, 9216
  buffer_load_dwordx4 v4, s[32:35], s40 offen lds
  s_add_u32 m0, m0, 1024
  s_add_u32 s40, s40, 9216
  buffer_load_dwordx4 v5, s[32:35], s40 offen lds
  s_add_u32 m0, m0, 1024
  s_add_u32 s40, s40, 9216
  buffer_load_dwordx4 v4, s[32:35], s40 offen lds
  s_add_u32 m0, m0, 1024
  s_add_u32 s40, s40, 9216
  buffer_load_dwordx4 v5, s[32:35], s40 offen lds
  s_add_u32 m0, m0, 1024
  s_add_u32 s40, s40, 9216
  buffer_load_dwordx4 v4, s[32:35], s40 offen lds
  s_add_u32 m0, m0, 1024
  s_add_u32 s40, s40, 9216
  buffer_load_dwordx4 v5, s[32:35], s40 offen lds
  s_add_u32 m0, m0, 1024
  s_add_u32 s40, s40, 9216
  buffer_load_dwordx4 v4, s[32:35], s40 offen lds
  s_add_u32 m0, m0, 1024
  s_add_u32 s40, s40, 9216
  buffer_load_dwordx4 v5, s[32:35], s40 offen lds
  s_waitcnt vmcnt(16)
  s_barrier
  s_cmp_lg_u32 s43, 4
  s_cbranch_scc1 L_bx_rx_4
  s_barrier
L_bx_rx_4:
  s_mov_b32 m0, 81920
  s_add_u32 s40, s41, 640
  buffer_load_dwordx4 v4, s[32:35], s40 offen lds
  s_add_u32 m0, m0, 1024
  s_add_u32 s40, s40, 9216
  buffer_load_dwordx4 v5, s[32:35], s40 offen lds
  s_add_u32 m0, m0, 1024
  s_add_u32 s40, s40, 9216
  buffer_load_dwordx4 v4, s[32:35], s40 offen lds
  s_add_u32 m0, m0, 1024
  s_add_u32 s40, s40, 9216
  buffer_load_dwordx4 v5, s[32:35], s40 offen lds
  s_add_u32 m0, m0, 1024
  s_add_u32 s40, s40, 9216
  buffer_load_dwordx4 v4, s[32:35], s40 offen lds
  s_add_u32 m0, m0, 1024
  s_add_u32 s40, s40, 9216
  buffer_load_dwordx4 v5, s[32:35], s40 offen lds
  s_add_u32 m0, m0, 1024
  s_add_u32 s40, s40, 9216
  buffer_load_dwordx4 v4, s[32:35], s40 offen lds
  s_add_u32 m0, m0, 1024
  s_add_u32 s40, s40, 9216
  buffer_load_dwordx4 v5, s[32:35], s40 offen lds
  s_add_u32 m0, m0, 1024
  s_add_u32 s40, s40, 9216
  buffer_load_dwordx4 v4, s[32:35], s40 offen lds
  s_add_u32 m0, m0, 1024
  s_add_u32 s40, s40, 9216
  buffer_load_dwordx4 v5, s[32:35], s40 offen lds
  s_add_u32 m0, m0, 1024
  s_add_u32 s40, s40, 9216
  buffer_load_dwordx4 v4, s[32:35], s40 offen lds
  s_add_u32 m0, m0, 1024
  s_add_u32 s40, s40, 9216
  buffer_load_dwordx4 v5, s[32:35], s40 offen lds
  s_add_u32 m0, m0, 1024
  s_add_u32 s40, s40, 9216
  buffer_load_dwordx4 v4, s[32:35], s40 offen lds
  s_add_u32 m0, m0, 1024
  s_add_u32 s40, s40, 9216
  buffer_load_dwordx4 v5, s[32:35], s40 offen lds
  s_add_u32 m0, m0, 1024
  s_add_u32 s40, s40, 9216
  buffer_load_dwordx4 v4, s[32:35], s40 offen lds
  s_add_u32 m0, m0, 1024
  s_add_u32 s40, s40, 9216
  buffer_load_dwordx4 v5, s[32:35], s40 offen lds
  s_waitcnt vmcnt(16)
  s_barrier
  s_cmp_lg_u32 s43, 5
  s_cbranch_scc1 L_bx_rx_5
  s_barrier
L_bx_rx_5:
  s_mov_b32 m0, 16384
  s_add_u32 s40, s41, 768
  buffer_load_dwordx4 v4, s[32:35], s40 offen lds
  s_add_u32 m0, m0, 1024
  s_add_u32 s40, s40, 9216
  buffer_load_dwordx4 v5, s[32:35], s40 offen lds
  s_add_u32 m0, m0, 1024
  s_add_u32 s40, s40, 9216
  buffer_load_dwordx4 v4, s[32:35], s40 offen lds
  s_add_u32 m0, m0, 1024
  s_add_u32 s40, s40, 9216
  buffer_load_dwordx4 v5, s[32:35], s40 offen lds
  s_add_u32 m0, m0, 1024
  s_add_u32 s40, s40, 9216
  buffer_load_dwordx4 v4, s[32:35], s40 offen lds
  s_add_u32 m0, m0, 1024
  s_add_u32 s40, s40, 9216
  buffer_load_dwordx4 v5, s[32:35], s40 offen lds
  s_add_u32 m0, m0, 1024
  s_add_u32 s40, s40, 9216
  buffer_load_dwordx4 v4, s[32:35], s40 offen lds
  s_add_u32 m0, m0, 1024
  s_add_u32 s40, s40, 9216
  buffer_load_dwordx4 v5, s[32:35], s40 offen lds
  s_add_u32 m0, m0, 1024
  s_add_u32 s40, s40, 9216
  buffer_load_dwordx4 v4, s[32:35], s40 offen lds
  s_add_u32 m0, m0, 1024
  s_add_u32 s40, s40, 9216
  buffer_load_dwordx4 v5, s[32:35], s40 offen lds
  s_add_u32 m0, m0, 1024
  s_add_u32 s40, s40, 9216
  buffer_load_dwordx4 v4, s[32:35], s40 offen lds
  s_add_u32 m0, m0, 1024
  s_add_u32 s40, s40, 9216
  buffer_load_dwordx4 v5, s[32:35], s40 offen lds
  s_add_u32 m0, m0, 1024
  s_add_u32 s40, s40, 9216
  buffer_load_dwordx4 v4, s[32:35], s40 offen lds
  s_add_u32 m0, m0, 1024
  s_add_u32 s40, s40, 9216
  buffer_load_dwordx4 v5, s[32:35], s40 offen lds
  s_add_u32 m0, m0, 1024
  s_add_u32 s40, s40, 9216
  buffer_load_dwordx4 v4, s[32:35], s40 offen lds
  s_add_u32 m0, m0, 1024
  s_add_u32 s40, s40, 9216
  buffer_load_dwordx4 v5, s[32:35], s40 offen lds
  s_waitcnt vmcnt(16)
  s_barrier
  s_cmp_lg_u32 s43, 6
  s_cbranch_scc1 L_bx_rx_6
  s_barrier
L_bx_rx_6:
  s_mov_b32 m0, 49152
  s_add_u32 s40, s41, 896
  buffer_load_dwordx4 v4, s[32:35], s40 offen lds
  s_add_u32 m0, m0, 1024
  s_add_u32 s40, s40, 9216
  buffer_load_dwordx4 v5, s[32:35], s40 offen lds
  s_add_u32 m0, m0, 1024
  s_add_u32 s40, s40, 9216
  buffer_load_dwordx4 v4, s[32:35], s40 offen lds
  s_add_u32 m0, m0, 1024
  s_add_u32 s40, s40, 9216
  buffer_load_dwordx4 v5, s[32:35], s40 offen lds
  s_add_u32 m0, m0, 1024
  s_add_u32 s40, s40, 9216
  buffer_load_dwordx4 v4, s[32:35], s40 offen lds
  s_add_u32 m0, m0, 1024
  s_add_u32 s40, s40, 9216
  buffer_load_dwordx4 v5, s[32:35], s40 offen lds
  s_add_u32 m0, m0, 1024
  s_add_u32 s40, s40, 9216
  buffer_load_dwordx4 v4, s[32:35], s40 offen lds
  s_add_u32 m0, m0, 1024
  s_add_u32 s40, s40, 9216
  buffer_load_dwordx4 v5, s[32:35], s40 offen lds
  s_add_u32 m0, m0, 1024
  s_add_u32 s40, s40, 9216
  buffer_load_dwordx4 v4, s[32:35], s40 offen lds
  s_add_u32 m0, m0, 1024
  s_add_u32 s40, s40, 9216
  buffer_load_dwordx4 v5, s[32:35], s40 offen lds
  s_add_u32 m0, m0, 1024
  s_add_u32 s40, s40, 9216
  buffer_load_dwordx4 v4, s[32:35], s40 offen lds
  s_add_u32 m0, m0, 1024
  s_add_u32 s40, s40, 9216
  buffer_load_dwordx4 v5, s[32:35], s40 offen lds
  s_add_u32 m0, m0, 1024
  s_add_u32 s40, s40, 9216
  buffer_load_dwordx4 v4, s[32:35], s40 offen lds
  s_add_u32 m0, m0, 1024
  s_add_u32 s40, s40, 9216
  buffer_load_dwordx4 v5, s[32:35], s40 offen lds
  s_add_u32 m0, m0, 1024
  s_add_u32 s40, s40, 9216
  buffer_load_dwordx4 v4, s[32:35], s40 offen lds
  s_add_u32 m0, m0, 1024
  s_add_u32 s40, s40, 9216
  buffer_load_dwordx4 v5, s[32:35], s40 offen lds
  s_waitcnt vmcnt(16)
  s_barrier
  s_mov_b32 m0, 81920
  s_add_u32 s40, s41, 1024
  buffer_load_dwordx4 v4, s[32:35], s40 offen lds
  s_add_u32 m0, m0, 1024
  s_add_u32 s40, s40, 9216
  buffer_load_dwordx4 v5, s[32:35], s40 offen lds
  s_add_u32 m0, m0, 1024
  s_add_u32 s40, s40, 9216
  buffer_load_dwordx4 v4, s[32:35], s40 offen lds
  s_add_u32 m0, m0, 1024
  s_add_u32 s40, s40, 9216
  buffer_load_dwordx4 v5, s[32:35], s40 offen lds
  s_add_u32 m0, m0, 1024
  s_add_u32 s40, s40, 9216
  buffer_load_dwordx4 v4, s[32:35], s40 offen lds
  s_add_u32 m0, m0, 1024
  s_add_u32 s40, s40, 9216
  buffer_load_dwordx4 v5, s[32:35], s40 offen lds
  s_add_u32 m0, m0, 1024
  s_add_u32 s40, s40, 9216
  buffer_load_dwordx4 v4, s[32:35], s40 offen lds
  s_add_u32 m0, m0, 1024
  s_add_u32 s40, s40, 9216
  buffer_load_dwordx4 v5, s[32:35], s40 offen lds
  s_add_u32 m0, m0, 1024
  s_add_u32 s40, s40, 9216
  buffer_load_dwordx4 v4, s[32:35], s40 offen lds
  s_add_u32 m0, m0, 1024
  s_add_u32 s40, s40, 9216
  buffer_load_dwordx4 v5, s[32:35], s40 offen lds
  s_add_u32 m0, m0, 1024
  s_add_u32 s40, s40, 9216
  buffer_load_dwordx4 v4, s[32:35], s40 offen lds
  s_add_u32 m0, m0, 1024
  s_add_u32 s40, s40, 9216
  buffer_load_dwordx4 v5, s[32:35], s40 offen lds
  s_add_u32 m0, m0, 1024
  s_add_u32 s40, s40, 9216
  buffer_load_dwordx4 v4, s[32:35], s40 offen lds
  s_add_u32 m0, m0, 1024
  s_add_u32 s40, s40, 9216
  buffer_load_dwordx4 v5, s[32:35], s40 offen lds
  s_add_u32 m0, m0, 1024
  s_add_u32 s40, s40, 9216
  buffer_load_dwordx4 v4, s[32:35], s40 offen lds
  s_add_u32 m0, m0, 1024
  s_add_u32 s40, s40, 9216
  buffer_load_dwordx4 v5, s[32:35], s40 offen lds
  s_waitcnt vmcnt(16)
  s_barrier
  s_mov_b32 s52, s24
  s_and_b32 s53, s25, 0xffff
  s_mov_b32 s54, 4718592
  s_mov_b32 s55, 0x00020000
  v_add_u32 v1, 0, v0
  v_mul_u32_u24 v2, 3641, v1
  v_lshrrev_b32 v2, 16, v2
  v_mul_u32_u24 v3, 18, v2
  v_sub_u32 v3, v1, v3
  v_lshlrev_b32 v3, 4, v3
  v_mul_u32_u24 v2, 1152, v2
  v_add_u32 v16, v2, v3
  v_add_u32 v1, 64, v0
  v_mul_u32_u24 v2, 3641, v1
  v_lshrrev_b32 v2, 16, v2
  v_mul_u32_u24 v3, 18, v2
  v_sub_u32 v3, v1, v3
  v_lshlrev_b32 v3, 4, v3
  v_mul_u32_u24 v2, 1152, v2
  v_add_u32 v17, v2, v3
  v_add_u32 v1, 128, v0
  v_mul_u32_u24 v2, 3641, v1
  v_lshrrev_b32 v2, 16, v2
  v_mul_u32_u24 v3, 18, v2
  v_sub_u32 v3, v1, v3
  v_lshlrev_b32 v3, 4, v3
  v_mul_u32_u24 v2, 1152, v2
  v_add_u32 v18, v2, v3
  v_add_u32 v1, 192, v0
  v_mul_u32_u24 v2, 3641, v1
  v_lshrrev_b32 v2, 16, v2
  v_mul_u32_u24 v3, 18, v2
  v_sub_u32 v3, v1, v3
  v_lshlrev_b32 v3, 4, v3
  v_mul_u32_u24 v2, 1152, v2
  v_add_u32 v19, v2, v3
  v_add_u32 v1, 256, v0
  v_mul_u32_u24 v2, 3641, v1
  v_lshrrev_b32 v2, 16, v2
  v_mul_u32_u24 v3, 18, v2
  v_sub_u32 v3, v1, v3
  v_lshlrev_b32 v3, 4, v3
  v_mul_u32_u24 v2, 1152, v2
  v_add_u32 v20, v2, v3
  v_add_u32 v1, 320, v0
  v_mul_u32_u24 v2, 3641, v1
  v_lshrrev_b32 v2, 16, v2
  v_mul_u32_u24 v3, 18, v2
  v_sub_u32 v3, v1, v3
  v_lshlrev_b32 v3, 4, v3
  v_mul_u32_u24 v2, 1152, v2
  v_add_u32 v21, v2, v3
  v_add_u32 v1, 384, v0
  v_mul_u32_u24 v2, 3641, v1
  v_lshrrev_b32 v2, 16, v2
  v_mul_u32_u24 v3, 18, v2
  v_sub_u32 v3, v1, v3
  v_lshlrev_b32 v3, 4, v3
  v_mul_u32_u24 v2, 1152, v2
  v_add_u32 v22, v2, v3
  v_add_u32 v1, 448, v0
  v_mul_u32_u24 v2, 3641, v1
  v_lshrrev_b32 v2, 16, v2
  v_mul_u32_u24 v3, 18, v2
  v_sub_u32 v3, v1, v3
  v_lshlrev_b32 v3, 4, v3
  v_mul_u32_u24 v2, 1152, v2
  v_add_u32 v23, v2, v3
  v_add_u32 v1, 512, v0
  v_mul_u32_u24 v2, 3641, v1
  v_lshrrev_b32 v2, 16, v2
  v_mul_u32_u24 v3, 18, v2
  v_sub_u32 v3, v1, v3
  v_lshlrev_b32 v3, 4, v3
  v_mul_u32_u24 v2, 1152, v2
  v_add_u32 v24, v2, v3
  s_mul_i32 s56, s6, 288
  s_waitcnt vmcnt(0)
  s_barrier
  s_barrier
  s_add_u32 s57, s6, 0
  s_and_b32 s57, s57, 3
  s_lshl_b32 s58, s4, 2
  s_add_u32 s57, s57, s58
  s_mul_i32 s57, s57, 147456
  s_add_u32 s57, s57, s56
  s_add_u32 s57, s57, 73728
  s_mov_b32 m0, 18432
  s_nop 0
  buffer_load_dwordx4 v16, s[52:55], s57 offen lds
  s_add_u32 m0, m0, 1024
  s_nop 0
  buffer_load_dwordx4 v17, s[52:55], s57 offen lds
  s_add_u32 m0, m0, 1024
  s_nop 0
  buffer_load_dwordx4 v18, s[52:55], s57 offen lds
  s_add_u32 m0, m0, 1024
  s_nop 0
  buffer_load_dwordx4 v19, s[52:55], s57 offen lds
  s_add_u32 m0, m0, 1024
  s_nop 0
  buffer_load_dwordx4 v20, s[52:55], s57 offen lds
  s_add_u32 m0, m0, 1024
  s_nop 0
  buffer_load_dwordx4 v21, s[52:55], s57 offen lds
  s_add_u32 m0, m0, 1024
  s_nop 0
  buffer_load_dwordx4 v22, s[52:55], s57 offen lds
  s_add_u32 m0, m0, 1024
  s_nop 0
  buffer_load_dwordx4 v23, s[52:55], s57 offen lds
  s_add_u32 m0, m0, 1024
  s_nop 0
  buffer_load_dwordx4 v24, s[52:55], s57 offen lds
  s_add_u32 m0, m0, 1024
  s_add_u32 s57, s57, 36864
  buffer_load_dwordx4 v16, s[52:55], s57 offen lds
  s_add_u32 m0, m0, 1024
  s_nop 0
  buffer_load_dwordx4 v17, s[52:55], s57 offen lds
  s_add_u32 m0, m0, 1024
  s_nop 0
  buffer_load_dwordx4 v18, s[52:55], s57 offen lds
  s_add_u32 m0, m0, 1024
  s_nop 0
  buffer_load_dwordx4 v19, s[52:55], s57 offen lds
  s_add_u32 m0, m0, 1024
  s_nop 0
  buffer_load_dwordx4 v20, s[52:55], s57 offen lds
  s_add_u32 m0, m0, 1024
  s_nop 0
  buffer_load_dwordx4 v21, s[52:55], s57 offen lds
  s_add_u32 m0, m0, 1024
  s_nop 0
  buffer_load_dwordx4 v22, s[52:55], s57 offen lds
  s_add_u32 m0, m0, 1024
  s_nop 0
  buffer_load_dwordx4 v23, s[52:55], s57 offen lds
  s_add_u32 m0, m0, 1024
  s_nop 0
  buffer_load_dwordx4 v24, s[52:55], s57 offen lds
  s_add_u32 s57, s6, 1
  s_and_b32 s57, s57, 3
  s_lshl_b32 s58, s4, 2
  s_add_u32 s57, s57, s58
  s_mul_i32 s57, s57, 147456
  s_add_u32 s57, s57, s56
  s_add_u32 s57, s57, 73728
  s_mov_b32 m0, 55296
  s_nop 0
  buffer_load_dwordx4 v16, s[52:55], s57 offen lds
  s_add_u32 m0, m0, 1024
  s_nop 0
  buffer_load_dwordx4 v17, s[52:55], s57 offen lds
  s_add_u32 m0, m0, 1024
  s_nop 0
  buffer_load_dwordx4 v18, s[52:55], s57 offen lds
  s_add_u32 m0, m0, 1024
  s_nop 0
  buffer_load_dwordx4 v19, s[52:55], s57 offen lds
  s_add_u32 m0, m0, 1024
  s_nop 0
  buffer_load_dwordx4 v20, s[52:55], s57 offen lds
  s_add_u32 m0, m0, 1024
  s_nop 0
  buffer_load_dwordx4 v21, s[52:55], s57 offen lds
  s_add_u32 m0, m0, 1024
  s_nop 0
  buffer_load_dwordx4 v22, s[52:55], s57 offen lds
  s_add_u32 m0, m0, 1024
  s_nop 0
  buffer_load_dwordx4 v23, s[52:55], s57 offen lds
  s_add_u32 m0, m0, 1024
  s_nop 0
  buffer_load_dwordx4 v24, s[52:55], s57 offen lds
  s_add_u32 m0, m0, 1024
  s_add_u32 s57, s57, 36864
  buffer_load_dwordx4 v16, s[52:55], s57 offen lds
  s_add_u32 m0, m0, 1024
  s_nop 0
  buffer_load_dwordx4 v17, s[52:55], s57 offen lds
  s_add_u32 m0, m0, 1024
  s_nop 0
  buffer_load_dwordx4 v18, s[52:55], s57 offen lds
  s_add_u32 m0, m0, 1024
  s_nop 0
  buffer_load_dwordx4 v19, s[52:55], s57 offen lds
  s_add_u32 m0, m0, 1024
  s_nop 0
  buffer_load_dwordx4 v20, s[52:55], s57 offen lds
  s_add_u32 m0, m0, 1024
  s_nop 0
  buffer_load_dwordx4 v21, s[52:55], s57 offen lds
  s_add_u32 m0, m0, 1024
  s_nop 0
  buffer_load_dwordx4 v22, s[52:55], s57 offen lds
  s_add_u32 m0, m0, 1024
  s_nop 0
  buffer_load_dwordx4 v23, s[52:55], s57 offen lds
  s_add_u32 m0, m0, 1024
  s_nop 0
  buffer_load_dwordx4 v24, s[52:55], s57 offen lds
  s_waitcnt vmcnt(18)
  s_barrier
  s_add_u32 s57, s6, 2
  s_and_b32 s57, s57, 3
  s_lshl_b32 s58, s4, 2
  s_add_u32 s57, s57, s58
  s_mul_i32 s57, s57, 147456
  s_add_u32 s57, s57, s56
  s_add_u32 s57, s57, 36864
  s_mov_b32 m0, 82944
  s_nop 0
  buffer_load_dwordx4 v16, s[52:55], s57 offen lds
  s_add_u32 m0, m0, 1024
  s_nop 0
  buffer_load_dwordx4 v17, s[52:55], s57 offen lds
  s_add_u32 m0, m0, 1024
  s_nop 0
  buffer_load_dwordx4 v18, s[52:55], s57 offen lds
  s_add_u32 m0, m0, 1024
  s_nop 0
  buffer_load_dwordx4 v19, s[52:55], s57 offen lds
  s_add_u32 m0, m0, 1024
  s_nop 0
  buffer_load_dwordx4 v20, s[52:55], s57 offen lds
  s_add_u32 m0, m0, 1024
  s_nop 0
  buffer_load_dwordx4 v21, s[52:55], s57 offen lds
  s_add_u32 m0, m0, 1024
  s_nop 0
  buffer_load_dwordx4 v22, s[52:55], s57 offen lds
  s_add_u32 m0, m0, 1024
  s_nop 0
  buffer_load_dwordx4 v23, s[52:55], s57 offen lds
  s_add_u32 m0, m0, 1024
  s_nop 0
  buffer_load_dwordx4 v24, s[52:55], s57 offen lds
  s_add_u32 s57, s6, 3
  s_and_b32 s57, s57, 3
  s_lshl_b32 s58, s4, 2
  s_add_u32 s57, s57, s58
  s_mul_i32 s57, s57, 147456
  s_add_u32 s57, s57, s56
  s_add_u32 s57, s57, 36864
  s_mov_b32 m0, 119808
  s_nop 0
  buffer_load_dwordx4 v16, s[52:55], s57 offen lds
  s_add_u32 m0, m0, 1024
  s_nop 0
  buffer_load_dwordx4 v17, s[52:55], s57 offen lds
  s_add_u32 m0, m0, 1024
  s_nop 0
  buffer_load_dwordx4 v18, s[52:55], s57 offen lds
  s_add_u32 m0, m0, 1024
  s_nop 0
  buffer_load_dwordx4 v19, s[52:55], s57 offen lds
  s_add_u32 m0, m0, 1024
  s_nop 0
  buffer_load_dwordx4 v20, s[52:55], s57 offen lds
  s_add_u32 m0, m0, 1024
  s_nop 0
  buffer_load_dwordx4 v21, s[52:55], s57 offen lds
  s_add_u32 m0, m0, 1024
  s_nop 0
  buffer_load_dwordx4 v22, s[52:55], s57 offen lds
  s_add_u32 m0, m0, 1024
  s_nop 0
  buffer_load_dwordx4 v23, s[52:55], s57 offen lds
  s_add_u32 m0, m0, 1024
  s_nop 0
  buffer_load_dwordx4 v24, s[52:55], s57 offen lds
  s_waitcnt vmcnt(18)
  s_barrier
  s_waitcnt vmcnt(9)
  s_barrier
  s_waitcnt vmcnt(0)
  s_barrier
  s_endpgm
L_a_ldv:
  s_waitcnt lgkmcnt(0)
  s_mov_b32 s32, s20
  s_and_b32 s33, s21, 0xffff
  s_mov_b32 s34, 8388608
  s_mov_b32 s35, 0x00020000
  s_cmp_lg_u32 s2, 0
  s_cbranch_scc1 L_nononce
  s_mov_b32 s48, s28
  s_and_b32 s49, s29, 0xffff
  s_mov_b32 s50, 256
  s_mov_b32 s51, 0x00020000
  s_memrealtime s[42:43]
  s_waitcnt lgkmcnt(0)
  s_or_b32 s42, s42, 1
  v_mov_b32 v8, s42
  v_mov_b32 v9, s43
  v_mov_b32 v1, 0
  s_mov_b64 exec, 1
  buffer_store_dwordx2 v[8:9], v1, s[48:51], 0 offen sc1
  s_mov_b64 exec, -1
L_nononce:
  s_mov_b32 s48, s28
  s_and_b32 s49, s29, 0xffff
  s_mov_b32 s50, 256
  s_mov_b32 s51, 0x00020000
  s_getreg_b32 s42, hwreg(HW_REG_XCC_ID)
  s_and_b32 s42, s42, 15
  s_cmp_ge_u32 s42, 8
  s_cbranch_scc1 L_noxcc
  s_mul_i32 s43, s42, s42
  s_lshl_b32 s43, s43, 5
  s_add_u32 s42, s42, s43
  s_add_u32 s42, s42, 0x2000
  s_lshl_b32 s43, s9, 3
  s_add_u32 s43, s43, s4
  s_and_b32 s41, s43, 1
  s_lshl_b32 s41, s41, 4
  s_lshl_b32 s42, s42, s41
  s_lshr_b32 s43, s43, 1
  s_lshl_b32 s43, s43, 2
  s_add_u32 s43, s43, 128
  v_mov_b32 v8, s42
  v_mov_b32 v1, 0
  s_mov_b64 exec, 1
  buffer_atomic_add v8, v1, s[48:51], s43 offen
  s_mov_b64 exec, -1
L_noxcc:
  v_lshrrev_b32 v1, 4, v0
  v_and_b32 v2, 15, v0
  v_lshlrev_b32 v3, 1, v1
  v_xor_b32 v2, v2, v3
  v_lshlrev_b32 v2, 4, v2
  v_lshl_add_u32 v4, v1, 8, v2
  v_xor_b32 v5, 128, v4
  s_mov_b32 s52, s24
  s_and_b32 s53, s25, 0xffff
  s_mov_b32 s54, 4718592
  s_mov_b32 s55, 0x00020000
  v_add_u32 v1, 0, v0
  v_mul_u32_u24 v2, 3641, v1
  v_lshrrev_b32 v2, 16, v2
  v_mul_u32_u24 v3, 18, v2
  v_sub_u32 v3, v1, v3
  v_lshlrev_b32 v3, 4, v3
  v_mul_u32_u24 v2, 1152, v2
  v_add_u32 v16, v2, v3
  v_add_u32 v1, 64, v0
  v_mul_u32_u24 v2, 3641, v1
  v_lshrrev_b32 v2, 16, v2
  v_mul_u32_u24 v3, 18, v2
  v_sub_u32 v3, v1, v3
  v_lshlrev_b32 v3, 4, v3
  v_mul_u32_u24 v2, 1152, v2
  v_add_u32 v17, v2, v3
  v_add_u32 v1, 128, v0
  v_mul_u32_u24 v2, 3641, v1
  v_lshrrev_b32 v2, 16, v2
  v_mul_u32_u24 v3, 18, v2
  v_sub_u32 v3, v1, v3
  v_lshlrev_b32 v3, 4, v3
  v_mul_u32_u24 v2, 1152, v2
  v_add_u32 v18, v2, v3
  v_add_u32 v1, 192, v0
  v_mul_u32_u24 v2, 3641, v1
  v_lshrrev_b32 v2, 16, v2
  v_mul_u32_u24 v3, 18, v2
  v_sub_u32 v3, v1, v3
  v_lshlrev_b32 v3, 4, v3
  v_mul_u32_u24 v2, 1152, v2
  v_add_u32 v19, v2, v3
  v_add_u32 v1, 256, v0
  v_mul_u32_u24 v2, 3641, v1
  v_lshrrev_b32 v2, 16, v2
  v_mul_u32_u24 v3, 18, v2
  v_sub_u32 v3, v1, v3
  v_lshlrev_b32 v3, 4, v3
  v_mul_u32_u24 v2, 1152, v2
  v_add_u32 v20, v2, v3
  v_add_u32 v1, 320, v0
  v_mul_u32_u24 v2, 3641, v1
  v_lshrrev_b32 v2, 16, v2
  v_mul_u32_u24 v3, 18, v2
  v_sub_u32 v3, v1, v3
  v_lshlrev_b32 v3, 4, v3
  v_mul_u32_u24 v2, 1152, v2
  v_add_u32 v21, v2, v3
  v_add_u32 v1, 384, v0
  v_mul_u32_u24 v2, 3641, v1
  v_lshrrev_b32 v2, 16, v2
  v_mul_u32_u24 v3, 18, v2
  v_sub_u32 v3, v1, v3
  v_lshlrev_b32 v3, 4, v3
  v_mul_u32_u24 v2, 1152, v2
  v_add_u32 v22, v2, v3
  v_add_u32 v1, 448, v0
  v_mul_u32_u24 v2, 3641, v1
  v_lshrrev_b32 v2, 16, v2
  v_mul_u32_u24 v3, 18, v2
  v_sub_u32 v3, v1, v3
  v_lshlrev_b32 v3, 4, v3
  v_mul_u32_u24 v2, 1152, v2
  v_add_u32 v23, v2, v3
  v_add_u32 v1, 512, v0
  v_mul_u32_u24 v2, 3641, v1
  v_lshrrev_b32 v2, 16, v2
  v_mul_u32_u24 v3, 18, v2
  v_sub_u32 v3, v1, v3
  v_lshlrev_b32 v3, 4, v3
  v_mul_u32_u24 v2, 1152, v2
  v_add_u32 v24, v2, v3
  s_mul_i32 s56, s6, 288
  s_and_b32 s43, s9, 3
  s_lshl_b32 s43, s43, 2
  s_lshr_b32 s43, 30000, s43
  s_and_b32 s43, s43, 15
  s_barrier
  s_mov_b32 s59, 0
L_v_loop:
  s_cmp_lg_u32 s59, s43
  s_cbranch_scc1 L_v_skip
  s_lshl_b32 s40, s9, 7
  s_add_u32 s40, s40, s10
  s_lshl_b32 s40, s40, 13
  s_mov_b32 m0, 131072
  s_nop 0
  buffer_load_dwordx4 v4, s[32:35], s40 offen nt lds
  buffer_load_dwordx4 v4, s[32:35], s40 offen offset:1024 nt lds
  buffer_load_dwordx4 v5, s[32:35], s40 offen offset:2048 nt lds
  buffer_load_dwordx4 v5, s[32:35], s40 offen offset:3072 nt lds
  s_add_u32 s40, s40, 4096
  s_mov_b32 m0, 135168
  s_nop 0
  buffer_load_dwordx4 v4, s[32:35], s40 offen nt lds
  buffer_load_dwordx4 v4, s[32:35], s40 offen offset:1024 nt lds
  buffer_load_dwordx4 v5, s[32:35], s40 offen offset:2048 nt lds
  buffer_load_dwordx4 v5, s[32:35], s40 offen offset:3072 nt lds
  s_add_u32 s40, s40, 258048
  s_mov_b32 m0, 139264
  s_nop 0
  buffer_load_dwordx4 v4, s[32:35], s40 offen nt lds
  buffer_load_dwordx4 v4, s[32:35], s40 offen offset:1024 nt lds
  buffer_load_dwordx4 v5, s[32:35], s40 offen offset:2048 nt lds
  buffer_load_dwordx4 v5, s[32:35], s40 offen offset:3072 nt lds
  s_add_u32 s40, s40, 4096
  s_mov_b32 m0, 143360
  s_nop 0
  buffer_load_dwordx4 v4, s[32:35], s40 offen nt lds
  buffer_load_dwordx4 v4, s[32:35], s40 offen offset:1024 nt lds
  buffer_load_dwordx4 v5, s[32:35], s40 offen offset:2048 nt lds
  buffer_load_dwordx4 v5, s[32:35], s40 offen offset:3072 nt lds
  s_add_u32 s40, s40, 258048
  s_mov_b32 m0, 147456
  s_nop 0
  buffer_load_dwordx4 v4, s[32:35], s40 offen nt lds
  buffer_load_dwordx4 v4, s[32:35], s40 offen offset:1024 nt lds
  buffer_load_dwordx4 v5, s[32:35], s40 offen offset:2048 nt lds
  buffer_load_dwordx4 v5, s[32:35], s40 offen offset:3072 nt lds
  s_add_u32 s40, s40, 4096
  s_mov_b32 m0, 151552
  s_nop 0
  buffer_load_dwordx4 v4, s[32:35], s40 offen nt lds
  buffer_load_dwordx4 v4, s[32:35], s40 offen offset:1024 nt lds
  buffer_load_dwordx4 v5, s[32:35], s40 offen offset:2048 nt lds
  buffer_load_dwordx4 v5, s[32:35], s40 offen offset:3072 nt lds
  s_add_u32 s40, s40, 258048
  s_mov_b32 m0, 155648
  s_nop 0
  buffer_load_dwordx4 v4, s[32:35], s40 offen nt lds
  buffer_load_dwordx4 v4, s[32:35], s40 offen offset:1024 nt lds
  buffer_load_dwordx4 v5, s[32:35], s40 offen offset:2048 nt lds
  buffer_load_dwordx4 v5, s[32:35], s40 offen offset:3072 nt lds
  s_add_u32 s40, s40, 4096
  s_mov_b32 m0, 159744
  s_nop 0
  buffer_load_dwordx4 v4, s[32:35], s40 offen nt lds
  buffer_load_dwordx4 v4, s[32:35], s40 offen offset:1024 nt lds
  buffer_load_dwordx4 v5, s[32:35], s40 offen offset:2048 nt lds
  buffer_load_dwordx4 v5, s[32:35], s40 offen offset:3072 nt lds
  s_add_u32 s40, s40, 258048
  s_cmp_ge_u32 s59, 7
  s_cbranch_scc1 L_v_skip
  s_barrier
L_v_skip:
  s_barrier
  s_add_u32 s59, s59, 1
  s_cmp_le_u32 s59, 8
  s_cbranch_scc1 L_v_loop
  s_waitcnt vmcnt(0)
  s_barrier
  s_barrier
  s_add_u32 s57, s6, 2
  s_and_b32 s57, s57, 3
  s_lshl_b32 s58, s4, 2
  s_add_u32 s57, s57, s58
  s_mul_i32 s57, s57, 147456
  s_add_u32 s57, s57, s56
  s_add_u32 s57, s57, 110592
  s_mov_b32 m0, 101376
  s_nop 0
  buffer_load_dwordx4 v16, s[52:55], s57 offen lds
  s_add_u32 m0, m0, 1024
  s_nop 0
  buffer_load_dwordx4 v17, s[52:55], s57 offen lds
  s_add_u32 m0, m0, 1024
  s_nop 0
  buffer_load_dwordx4 v18, s[52:55], s57 offen lds
  s_add_u32 m0, m0, 1024
  s_nop 0
  buffer_load_dwordx4 v19, s[52:55], s57 offen lds
  s_add_u32 m0, m0, 1024
  s_nop 0
  buffer_load_dwordx4 v20, s[52:55], s57 offen lds
  s_add_u32 m0, m0, 1024
  s_nop 0
  buffer_load_dwordx4 v21, s[52:55], s57 offen lds
  s_add_u32 m0, m0, 1024
  s_nop 0
  buffer_load_dwordx4 v22, s[52:55], s57 offen lds
  s_add_u32 m0, m0, 1024
  s_nop 0
  buffer_load_dwordx4 v23, s[52:55], s57 offen lds
  s_add_u32 m0, m0, 1024
  s_nop 0
  buffer_load_dwordx4 v24, s[52:55], s57 offen lds
  s_add_u32 s57, s6, 3
  s_and_b32 s57, s57, 3
  s_lshl_b32 s58, s4, 2
  s_add_u32 s57, s57, s58
  s_mul_i32 s57, s57, 147456
  s_add_u32 s57, s57, s56
  s_add_u32 s57, s57, 110592
  s_mov_b32 m0, 138240
  s_nop 0
  buffer_load_dwordx4 v16, s[52:55], s57 offen lds
  s_add_u32 m0, m0, 1024
  s_nop 0
  buffer_load_dwordx4 v17, s[52:55], s57 offen lds
  s_add_u32 m0, m0, 1024
  s_nop 0
  buffer_load_dwordx4 v18, s[52:55], s57 offen lds
  s_add_u32 m0, m0, 1024
  s_nop 0
  buffer_load_dwordx4 v19, s[52:55], s57 offen lds
  s_add_u32 m0, m0, 1024
  s_nop 0
  buffer_load_dwordx4 v20, s[52:55], s57 offen lds
  s_add_u32 m0, m0, 1024
  s_nop 0
  buffer_load_dwordx4 v21, s[52:55], s57 offen lds
  s_add_u32 m0, m0, 1024
  s_nop 0
  buffer_load_dwordx4 v22, s[52:55], s57 offen lds
  s_add_u32 m0, m0, 1024
  s_nop 0
  buffer_load_dwordx4 v23, s[52:55], s57 offen lds
  s_add_u32 m0, m0, 1024
  s_nop 0
  buffer_load_dwordx4 v24, s[52:55], s57 offen lds
  s_barrier
  s_waitcnt vmcnt(9)
  s_barrier
  s_waitcnt vmcnt(0)
  s_barrier
  s_endpgm
L_a_ldk:
  s_waitcnt lgkmcnt(0)
  s_mov_b32 s32, s18
  s_and_b32 s33, s19, 0xffff
  s_mov_b32 s34, 8388608
  s_mov_b32 s35, 0x00020000
  v_lshrrev_b32 v1, 4, v0
  v_and_b32 v2, 15, v0
  v_xor_b32 v2, v2, v1
  v_lshlrev_b32 v2, 4, v2
  v_lshl_add_u32 v4, v1, 8, v2
  v_xor_b32 v5, 64, v4
  v_xor_b32 v6, 128, v4
  v_xor_b32 v7, 192, v4
  s_mov_b32 s52, s24
  s_and_b32 s53, s25, 0xffff
  s_mov_b32 s54, 4718592
  s_mov_b32 s55, 0x00020000
  v_add_u32 v1, 0, v0
  v_mul_u32_u24 v2, 3641, v1
  v_lshrrev_b32 v2, 16, v2
  v_mul_u32_u24 v3, 18, v2
  v_sub_u32 v3, v1, v3
  v_lshlrev_b32 v3, 4, v3
  v_mul_u32_u24 v2, 1152, v2
  v_add_u32 v16, v2, v3
  v_add_u32 v1, 64, v0
  v_mul_u32_u24 v2, 3641, v1
  v_lshrrev_b32 v2, 16, v2
  v_mul_u32_u24 v3, 18, v2
  v_sub_u32 v3, v1, v3
  v_lshlrev_b32 v3, 4, v3
  v_mul_u32_u24 v2, 1152, v2
  v_add_u32 v17, v2, v3
  v_add_u32 v1, 128, v0
  v_mul_u32_u24 v2, 3641, v1
  v_lshrrev_b32 v2, 16, v2
  v_mul_u32_u24 v3, 18, v2
  v_sub_u32 v3, v1, v3
  v_lshlrev_b32 v3, 4, v3
  v_mul_u32_u24 v2, 1152, v2
  v_add_u32 v18, v2, v3
  v_add_u32 v1, 192, v0
  v_mul_u32_u24 v2, 3641, v1
  v_lshrrev_b32 v2, 16, v2
  v_mul_u32_u24 v3, 18, v2
  v_sub_u32 v3, v1, v3
  v_lshlrev_b32 v3, 4, v3
  v_mul_u32_u24 v2, 1152, v2
  v_add_u32 v19, v2, v3
  v_add_u32 v1, 256, v0
  v_mul_u32_u24 v2, 3641, v1
  v_lshrrev_b32 v2, 16, v2
  v_mul_u32_u24 v3, 18, v2
  v_sub_u32 v3, v1, v3
  v_lshlrev_b32 v3, 4, v3
  v_mul_u32_u24 v2, 1152, v2
  v_add_u32 v20, v2, v3
  v_add_u32 v1, 320, v0
  v_mul_u32_u24 v2, 3641, v1
  v_lshrrev_b32 v2, 16, v2
  v_mul_u32_u24 v3, 18, v2
  v_sub_u32 v3, v1, v3
  v_lshlrev_b32 v3, 4, v3
  v_mul_u32_u24 v2, 1152, v2
  v_add_u32 v21, v2, v3
  v_add_u32 v1, 384, v0
  v_mul_u32_u24 v2, 3641, v1
  v_lshrrev_b32 v2, 16, v2
  v_mul_u32_u24 v3, 18, v2
  v_sub_u32 v3, v1, v3
  v_lshlrev_b32 v3, 4, v3
  v_mul_u32_u24 v2, 1152, v2
  v_add_u32 v22, v2, v3
  v_add_u32 v1, 448, v0
  v_mul_u32_u24 v2, 3641, v1
  v_lshrrev_b32 v2, 16, v2
  v_mul_u32_u24 v3, 18, v2
  v_sub_u32 v3, v1, v3
  v_lshlrev_b32 v3, 4, v3
  v_mul_u32_u24 v2, 1152, v2
  v_add_u32 v23, v2, v3
  v_add_u32 v1, 512, v0
  v_mul_u32_u24 v2, 3641, v1
  v_lshrrev_b32 v2, 16, v2
  v_mul_u32_u24 v3, 18, v2
  v_sub_u32 v3, v1, v3
  v_lshlrev_b32 v3, 4, v3
  v_mul_u32_u24 v2, 1152, v2
  v_add_u32 v24, v2, v3
  s_mul_i32 s56, s6, 288
  v_and_b32 v8, 15, v0
  v_mul_u32_u24 v8, 1152, v8
  v_lshrrev_b32 v9, 4, v0
  v_lshl_add_u32 v9, v9, 7, v8
  s_and_b32 s43, s9, 3
  s_lshl_b32 s43, s43, 2
  s_lshr_b32 s43, 30000, s43
  s_and_b32 s43, s43, 15
  s_mov_b32 s44, s30
  s_and_b32 s45, s31, 0xffff
  s_mov_b32 s46, 67108864
  s_mov_b32 s47, 0x00020000
  s_mov_b32 s48, s26
  s_and_b32 s49, s27, 0xffff
  s_mov_b32 s50, 1179648
  s_mov_b32 s51, 0x00020000
  s_lshl_b32 s40, s9, 5
  s_add_u32 s40, s40, s10
  s_lshl_b32 s40, s40, 15
  s_lshl_b32 s41, s9, 2
  s_add_u32 s41, s41, s6
  s_lshl_b32 s41, s41, 2
  s_mul_i32 s42, s41, 73728
  s_add_u32 s42, s42, 8388608
  s_mul_i32 s58, s4, 1152
  s_add_u32 s42, s42, s58
  s_lshl_b32 s41, s41, 8
  s_add_u32 s41, s41, 29884416
  v_mov_b32 v11, 0
  s_mov_b64 exec, 1
  buffer_load_dword v10, v11, s[44:47], s40 offen
  buffer_load_dword v10, v11, s[44:47], s42 offen
  buffer_load_dword v10, v11, s[44:47], s41 offen sc1
  s_lshl_b32 s40, s9, 7
  s_lshl_b32 s41, s4, 1
  s_add_u32 s40, s40, s41
  s_mul_i32 s40, s40, 1152
  s_mul_i32 s41, s6, 288
  s_add_u32 s40, s40, s41
  buffer_load_dword v10, v11, s[48:51], s40 offen
  s_mov_b64 exec, -1
  s_barrier
  s_mov_b32 s59, 0
L_k_loop:
  s_cmp_lg_u32 s59, s43
  s_cbranch_scc1 L_k_skip
  s_lshl_b32 s40, s4, 2
  s_add_u32 s40, s40, s6
  s_lshl_b32 s40, s40, 3
  s_add_u32 s40, s40, s9
  s_mul_i32 s40, s40, 18432
  s_mul_i32 s41, s6, 288
  s_and_b32 s41, s41, 0xffffff80
  s_add_u32 s40, s40, s41
  s_mov_b32 exec_lo, -1
  s_mov_b32 exec_hi, 0xffff
  buffer_load_dword v10, v9, s[52:55], s40 offen
  s_mov_b64 exec, -1
  s_lshl_b32 s40, s9, 7
  s_add_u32 s40, s40, s10
  s_lshl_b32 s40, s40, 13
  s_mov_b32 m0, 98304
  s_nop 0
  buffer_load_dwordx4 v4, s[32:35], s40 offen nt lds
  buffer_load_dwordx4 v4, s[32:35], s40 offen offset:1024 nt lds
  buffer_load_dwordx4 v5, s[32:35], s40 offen offset:2048 nt lds
  buffer_load_dwordx4 v5, s[32:35], s40 offen offset:3072 nt lds
  s_add_u32 s40, s40, 4096
  s_mov_b32 m0, 102400
  s_nop 0
  buffer_load_dwordx4 v6, s[32:35], s40 offen nt lds
  buffer_load_dwordx4 v6, s[32:35], s40 offen offset:1024 nt lds
  buffer_load_dwordx4 v7, s[32:35], s40 offen offset:2048 nt lds
  buffer_load_dwordx4 v7, s[32:35], s40 offen offset:3072 nt lds
  s_add_u32 s40, s40, 258048
  s_mov_b32 m0, 106496
  s_nop 0
  buffer_load_dwordx4 v4, s[32:35], s40 offen nt lds
  buffer_load_dwordx4 v4, s[32:35], s40 offen offset:1024 nt lds
  buffer_load_dwordx4 v5, s[32:35], s40 offen offset:2048 nt lds
  buffer_load_dwordx4 v5, s[32:35], s40 offen offset:3072 nt lds
  s_add_u32 s40, s40, 4096
  s_mov_b32 m0, 110592
  s_nop 0
  buffer_load_dwordx4 v6, s[32:35], s40 offen nt lds
  buffer_load_dwordx4 v6, s[32:35], s40 offen offset:1024 nt lds
  buffer_load_dwordx4 v7, s[32:35], s40 offen offset:2048 nt lds
  buffer_load_dwordx4 v7, s[32:35], s40 offen offset:3072 nt lds
  s_add_u32 s40, s40, 258048
  s_mov_b32 m0, 114688
  s_nop 0
  buffer_load_dwordx4 v4, s[32:35], s40 offen nt lds
  buffer_load_dwordx4 v4, s[32:35], s40 offen offset:1024 nt lds
  buffer_load_dwordx4 v5, s[32:35], s40 offen offset:2048 nt lds
  buffer_load_dwordx4 v5, s[32:35], s40 offen offset:3072 nt lds
  s_add_u32 s40, s40, 4096
  s_mov_b32 m0, 118784
  s_nop 0
  buffer_load_dwordx4 v6, s[32:35], s40 offen nt lds
  buffer_load_dwordx4 v6, s[32:35], s40 offen offset:1024 nt lds
  buffer_load_dwordx4 v7, s[32:35], s40 offen offset:2048 nt lds
  buffer_load_dwordx4 v7, s[32:35], s40 offen offset:3072 nt lds
  s_add_u32 s40, s40, 258048
  s_mov_b32 m0, 122880
  s_nop 0
  buffer_load_dwordx4 v4, s[32:35], s40 offen nt lds
  buffer_load_dwordx4 v4, s[32:35], s40 offen offset:1024 nt lds
  buffer_load_dwordx4 v5, s[32:35], s40 offen offset:2048 nt lds
  buffer_load_dwordx4 v5, s[32:35], s40 offen offset:3072 nt lds
  s_add_u32 s40, s40, 4096
  s_mov_b32 m0, 126976
  s_nop 0
  buffer_load_dwordx4 v6, s[32:35], s40 offen nt lds
  buffer_load_dwordx4 v6, s[32:35], s40 offen offset:1024 nt lds
  buffer_load_dwordx4 v7, s[32:35], s40 offen offset:2048 nt lds
  buffer_load_dwordx4 v7, s[32:35], s40 offen offset:3072 nt lds
  s_add_u32 s40, s40, 258048
  s_cmp_ge_u32 s59, 7
  s_cbranch_scc1 L_k_skip
  s_barrier
L_k_skip:
  s_cmp_lg_u32 s59, 8
  s_cbranch_scc1 L_k_skip2
  s_lshl_b32 s40, s4, 5
  s_add_u32 s40, s40, s5
  s_mul_i32 s40, s40, 18432
  buffer_load_dword v10, v9, s[52:55], s40 offen
  buffer_load_dword v10, v9, s[52:55], s40 offen offset:512
  s_mov_b64 exec, 0xffff
  buffer_load_dword v10, v8, s[52:55], s40 offen offset:1024
  s_mov_b64 exec, -1
L_k_skip2:
  s_barrier
  s_add_u32 s59, s59, 1
  s_cmp_le_u32 s59, 8
  s_cbranch_scc1 L_k_loop
  s_waitcnt vmcnt(3)
  s_barrier
  s_barrier
  s_add_u32 s57, s6, 2
  s_and_b32 s57, s57, 3
  s_lshl_b32 s58, s4, 2
  s_add_u32 s57, s57, s58
  s_mul_i32 s57, s57, 147456
  s_add_u32 s57, s57, s56
  s_add_u32 s57, s57, 73728
  s_mov_b32 m0, 92160
  s_nop 0
  buffer_load_dwordx4 v16, s[52:55], s57 offen lds
  s_add_u32 m0, m0, 1024
  s_nop 0
  buffer_load_dwordx4 v17, s[52:55], s57 offen lds
  s_add_u32 m0, m0, 1024
  s_nop 0
  buffer_load_dwordx4 v18, s[52:55], s57 offen lds
  s_add_u32 m0, m0, 1024
  s_nop 0
  buffer_load_dwordx4 v19, s[52:55], s57 offen lds
  s_add_u32 m0, m0, 1024
  s_nop 0
  buffer_load_dwordx4 v20, s[52:55], s57 offen lds
  s_add_u32 m0, m0, 1024
  s_nop 0
  buffer_load_dwordx4 v21, s[52:55], s57 offen lds
  s_add_u32 m0, m0, 1024
  s_nop 0
  buffer_load_dwordx4 v22, s[52:55], s57 offen lds
  s_add_u32 m0, m0, 1024
  s_nop 0
  buffer_load_dwordx4 v23, s[52:55], s57 offen lds
  s_add_u32 m0, m0, 1024
  s_nop 0
  buffer_load_dwordx4 v24, s[52:55], s57 offen lds
  s_add_u32 s57, s6, 3
  s_and_b32 s57, s57, 3
  s_lshl_b32 s58, s4, 2
  s_add_u32 s57, s57, s58
  s_mul_i32 s57, s57, 147456
  s_add_u32 s57, s57, s56
  s_add_u32 s57, s57, 73728
  s_mov_b32 m0, 129024
  s_nop 0
  buffer_load_dwordx4 v16, s[52:55], s57 offen lds
  s_add_u32 m0, m0, 1024
  s_nop 0
  buffer_load_dwordx4 v17, s[52:55], s57 offen lds
  s_add_u32 m0, m0, 1024
  s_nop 0
  buffer_load_dwordx4 v18, s[52:55], s57 offen lds
  s_add_u32 m0, m0, 1024
  s_nop 0
  buffer_load_dwordx4 v19, s[52:55], s57 offen lds
  s_add_u32 m0, m0, 1024
  s_nop 0
  buffer_load_dwordx4 v20, s[52:55], s57 offen lds
  s_add_u32 m0, m0, 1024
  s_nop 0
  buffer_load_dwordx4 v21, s[52:55], s57 offen lds
  s_add_u32 m0, m0, 1024
  s_nop 0
  buffer_load_dwordx4 v22, s[52:55], s57 offen lds
  s_add_u32 m0, m0, 1024
  s_nop 0
  buffer_load_dwordx4 v23, s[52:55], s57 offen lds
  s_add_u32 m0, m0, 1024
  s_nop 0
  buffer_load_dwordx4 v24, s[52:55], s57 offen lds
  s_barrier
  s_waitcnt vmcnt(9)
  s_barrier
  s_waitcnt vmcnt(0)
  s_barrier
  s_endpgm
L_a_compute:
  v_and_b32 v1, 31, v0
  v_lshrrev_b32 v2, 5, v0
  v_bfe_u32 v3, v0, 1, 3
  v_xor_b32 v2, v2, v3
  v_lshlrev_b32 v2, 4, v2
  v_lshl_add_u32 v2, v1, 7, v2
  s_lshl_b32 s40, s3, 12
  s_add_u32 s40, s40, 16384
  v_add_u32 v2, s40, v2
  v_xor_b32 v4, 0, v2
  v_add_u32 v8, 65536, v4
  v_xor_b32 v5, 32, v2
  v_add_u32 v9, 65536, v5
  v_xor_b32 v6, 64, v2
  v_add_u32 v10, 65536, v6
  v_xor_b32 v7, 96, v2
  v_add_u32 v11, 65536, v7
  v_bfe_u32 v1, v0, 2, 2
  v_lshrrev_b32 v2, 5, v0
  v_lshl_add_u32 v2, v2, 3, v1
  v_lshlrev_b32 v2, 8, v2
  v_and_b32 v3, 1, v0
  v_lshl_add_u32 v2, v3, 5, v2
  v_bfe_u32 v3, v0, 4, 1
  v_lshl_add_u32 v2, v3, 4, v2
  v_bfe_u32 v3, v0, 1, 1
  v_lshl_add_u32 v2, v3, 3, v2
  v_lshl_add_u32 v2, v1, 6, v2
  v_xor_b32 v12, 0, v2
  v_add_u32 v248, 65536, v12
  v_xor_b32 v13, 64, v2
  v_add_u32 v249, 65536, v13
  v_xor_b32 v14, 128, v2
  v_add_u32 v250, 65536, v14
  v_xor_b32 v15, 192, v2
  v_add_u32 v251, 65536, v15
  v_and_b32 v1, 15, v0
  v_lshrrev_b32 v2, 4, v0
  v_xor_b32 v2, v2, v1
  v_lshlrev_b32 v2, 4, v2
  v_lshrrev_b32 v3, 2, v1
  v_lshl_add_u32 v2, v3, 11, v2
  v_and_b32 v3, 3, v1
  v_lshl_add_u32 v2, v3, 8, v2
  s_lshl_b32 s40, s3, 13
  s_add_u32 s40, s40, 98304
  v_add_u32 v2, s40, v2
  v_xor_b32 v56, 0, v2
  v_xor_b32 v57, 64, v2
  v_xor_b32 v58, 128, v2
  v_xor_b32 v59, 192, v2
  v_lshrrev_b32 v1, 4, v0
  v_bfe_u32 v3, v0, 2, 2
  v_lshl_add_u32 v2, v1, 3, v3
  v_lshlrev_b32 v2, 8, v2
  v_and_b32 v1, 1, v1
  v_lshl_add_u32 v3, v1, 2, v3
  v_lshl_add_u32 v2, v3, 5, v2
  v_and_b32 v3, 3, v0
  v_lshl_add_u32 v2, v3, 3, v2
  s_lshl_b32 s40, s3, 13
  s_add_u32 s40, s40, 131072
  v_add_u32 v60, s40, v2
  s_waitcnt lgkmcnt(0)
  s_mov_b32 s36, s28
  s_and_b32 s37, s29, 0xffff
  s_mov_b32 s38, 256
  s_mov_b32 s39, 0x00020000
  v_mov_b32 v1, 0
  s_lshl_b32 s40, s9, 3
  s_add_u32 s40, s40, s4
  s_lshr_b32 s40, s40, 1
  s_lshl_b32 s40, s40, 2
  s_add_u32 s40, s40, 128
  s_mov_b32 s44, s30
  s_and_b32 s45, s31, 0xffff
  s_mov_b32 s46, 67108864
  s_mov_b32 s47, 0x00020000
  s_lshl_b32 s42, s9, 3
  s_add_u32 s42, s42, s4
  s_lshl_b32 s42, s42, 2
  s_add_u32 s42, s42, s3
  s_lshl_b32 s42, s42, 7
  s_add_u32 s42, s42, 29360128
  s_and_b32 s43, s9, 3
  s_lshl_b32 s43, s43, 2
  s_lshr_b32 s43, 30000, s43
  s_and_b32 s43, s43, 15
  s_barrier
  s_cmp_lg_u32 s43, 0
  s_cbranch_scc1 L_bx_c_0
  s_barrier
L_bx_c_0:
  s_barrier
  ds_read_b128 v[48:51], v4 offset:0
  ds_read_b64_tr_b16 v[16:17], v12 offset:0
  ds_read_b64_tr_b16 v[18:19], v12 offset:1024
  ds_read_b64_tr_b16 v[20:21], v13 offset:0
  ds_read_b64_tr_b16 v[22:23], v13 offset:1024
  ds_read_b64_tr_b16 v[24:25], v14 offset:0
  ds_read_b64_tr_b16 v[26:27], v14 offset:1024
  ds_read_b64_tr_b16 v[28:29], v15 offset:0
  ds_read_b64_tr_b16 v[30:31], v15 offset:1024
  s_waitcnt lgkmcnt(6)
  v_mfma_f32_32x32x16_bf16 v[64:79], v[16:19], v[48:51], 0
  ds_read_b128 v[52:55], v5 offset:0
  ds_read_b64_tr_b16 v[32:33], v12 offset:4096
  ds_read_b64_tr_b16 v[34:35], v12 offset:5120
  s_waitcnt lgkmcnt(7)
  v_mfma_f32_32x32x16_bf16 v[80:95], v[20:23], v[48:51], 0
  ds_read_b64_tr_b16 v[36:37], v13 offset:4096
  ds_read_b64_tr_b16 v[38:39], v13 offset:5120
  ds_read_b64_tr_b16 v[40:41], v14 offset:4096
  s_waitcnt lgkmcnt(8)
  v_mfma_f32_32x32x16_bf16 v[96:111], v[24:27], v[48:51], 0
  ds_read_b64_tr_b16 v[42:43], v14 offset:5120
  ds_read_b64_tr_b16 v[44:45], v15 offset:4096
  ds_read_b64_tr_b16 v[46:47], v15 offset:5120
  s_waitcnt lgkmcnt(9)
  v_mfma_f32_32x32x16_bf16 v[112:127], v[28:31], v[48:51], 0
  s_waitcnt lgkmcnt(6)
  v_mfma_f32_32x32x16_bf16 v[64:79], v[32:35], v[52:55], v[64:79]
  ds_read_b128 v[48:51], v6 offset:0
  ds_read_b64_tr_b16 v[16:17], v12 offset:8192
  ds_read_b64_tr_b16 v[18:19], v12 offset:9216
  s_waitcnt lgkmcnt(7)
  v_mfma_f32_32x32x16_bf16 v[80:95], v[36:39], v[52:55], v[80:95]
  ds_read_b64_tr_b16 v[20:21], v13 offset:8192
  ds_read_b64_tr_b16 v[22:23], v13 offset:9216
  ds_read_b64_tr_b16 v[24:25], v14 offset:8192
  s_waitcnt lgkmcnt(8)
  v_mfma_f32_32x32x16_bf16 v[96:111], v[40:43], v[52:55], v[96:111]
  ds_read_b64_tr_b16 v[26:27], v14 offset:9216
  ds_read_b64_tr_b16 v[28:29], v15 offset:8192
  ds_read_b64_tr_b16 v[30:31], v15 offset:9216
  s_waitcnt lgkmcnt(9)
  v_mfma_f32_32x32x16_bf16 v[112:127], v[44:47], v[52:55], v[112:127]
  s_waitcnt lgkmcnt(6)
  v_mfma_f32_32x32x16_bf16 v[64:79], v[16:19], v[48:51], v[64:79]
  ds_read_b128 v[52:55], v7 offset:0
  ds_read_b64_tr_b16 v[32:33], v12 offset:12288
  ds_read_b64_tr_b16 v[34:35], v12 offset:13312
  s_waitcnt lgkmcnt(7)
  v_mfma_f32_32x32x16_bf16 v[80:95], v[20:23], v[48:51], v[80:95]
  ds_read_b64_tr_b16 v[36:37], v13 offset:12288
  ds_read_b64_tr_b16 v[38:39], v13 offset:13312
  ds_read_b64_tr_b16 v[40:41], v14 offset:12288
  s_waitcnt lgkmcnt(8)
  v_mfma_f32_32x32x16_bf16 v[96:111], v[24:27], v[48:51], v[96:111]
  ds_read_b64_tr_b16 v[42:43], v14 offset:13312
  ds_read_b64_tr_b16 v[44:45], v15 offset:12288
  ds_read_b64_tr_b16 v[46:47], v15 offset:13312
  s_waitcnt lgkmcnt(9)
  v_mfma_f32_32x32x16_bf16 v[112:127], v[28:31], v[48:51], v[112:127]
  s_waitcnt lgkmcnt(6)
  v_mfma_f32_32x32x16_bf16 v[64:79], v[32:35], v[52:55], v[64:79]
  s_waitcnt lgkmcnt(4)
  v_mfma_f32_32x32x16_bf16 v[80:95], v[36:39], v[52:55], v[80:95]
  s_waitcnt lgkmcnt(2)
  v_mfma_f32_32x32x16_bf16 v[96:111], v[40:43], v[52:55], v[96:111]
  s_waitcnt lgkmcnt(0)
  s_cmp_lg_u32 s43, 1
  s_cbranch_scc1 L_bx_c_1
  s_barrier
L_bx_c_1:
  s_barrier
  ds_read_b128 v[48:51], v4 offset:32768
  ds_read_b64_tr_b16 v[16:17], v12 offset:32768
  ds_read_b64_tr_b16 v[18:19], v12 offset:33792
  ds_read_b64_tr_b16 v[20:21], v13 offset:32768
  ds_read_b64_tr_b16 v[22:23], v13 offset:33792
  v_mfma_f32_32x32x16_bf16 v[112:127], v[44:47], v[52:55], v[112:127]
  ds_read_b64_tr_b16 v[24:25], v14 offset:32768
  ds_read_b64_tr_b16 v[26:27], v14 offset:33792
  ds_read_b64_tr_b16 v[28:29], v15 offset:32768
  ds_read_b64_tr_b16 v[30:31], v15 offset:33792
  s_waitcnt lgkmcnt(6)
  v_mfma_f32_32x32x16_bf16 v[64:79], v[16:19], v[48:51], v[64:79]
  ds_read_b128 v[52:55], v5 offset:32768
  ds_read_b64_tr_b16 v[32:33], v12 offset:36864
  ds_read_b64_tr_b16 v[34:35], v12 offset:37888
  s_waitcnt lgkmcnt(7)
  v_mfma_f32_32x32x16_bf16 v[80:95], v[20:23], v[48:51], v[80:95]
  ds_read_b64_tr_b16 v[36:37], v13 offset:36864
  ds_read_b64_tr_b16 v[38:39], v13 offset:37888
  ds_read_b64_tr_b16 v[40:41], v14 offset:36864
  s_waitcnt lgkmcnt(8)
  v_mfma_f32_32x32x16_bf16 v[96:111], v[24:27], v[48:51], v[96:111]
  ds_read_b64_tr_b16 v[42:43], v14 offset:37888
  ds_read_b64_tr_b16 v[44:45], v15 offset:36864
  ds_read_b64_tr_b16 v[46:47], v15 offset:37888
  s_waitcnt lgkmcnt(9)
  v_mfma_f32_32x32x16_bf16 v[112:127], v[28:31], v[48:51], v[112:127]
  s_waitcnt lgkmcnt(6)
  v_mfma_f32_32x32x16_bf16 v[64:79], v[32:35], v[52:55], v[64:79]
  ds_read_b128 v[48:51], v6 offset:32768
  ds_read_b64_tr_b16 v[16:17], v12 offset:40960
  ds_read_b64_tr_b16 v[18:19], v12 offset:41984
  s_waitcnt lgkmcnt(7)
  v_mfma_f32_32x32x16_bf16 v[80:95], v[36:39], v[52:55], v[80:95]
  ds_read_b64_tr_b16 v[20:21], v13 offset:40960
  ds_read_b64_tr_b16 v[22:23], v13 offset:41984
  ds_read_b64_tr_b16 v[24:25], v14 offset:40960
  s_waitcnt lgkmcnt(8)
  v_mfma_f32_32x32x16_bf16 v[96:111], v[40:43], v[52:55], v[96:111]
  ds_read_b64_tr_b16 v[26:27], v14 offset:41984
  ds_read_b64_tr_b16 v[28:29], v15 offset:40960
  ds_read_b64_tr_b16 v[30:31], v15 offset:41984
  s_waitcnt lgkmcnt(9)
  v_mfma_f32_32x32x16_bf16 v[112:127], v[44:47], v[52:55], v[112:127]
  s_waitcnt lgkmcnt(6)
  v_mfma_f32_32x32x16_bf16 v[64:79], v[16:19], v[48:51], v[64:79]
  ds_read_b128 v[52:55], v7 offset:32768
  ds_read_b64_tr_b16 v[32:33], v12 offset:45056
  ds_read_b64_tr_b16 v[34:35], v12 offset:46080
  s_waitcnt lgkmcnt(7)
  v_mfma_f32_32x32x16_bf16 v[80:95], v[20:23], v[48:51], v[80:95]
  ds_read_b64_tr_b16 v[36:37], v13 offset:45056
  ds_read_b64_tr_b16 v[38:39], v13 offset:46080
  ds_read_b64_tr_b16 v[40:41], v14 offset:45056
  s_waitcnt lgkmcnt(8)
  v_mfma_f32_32x32x16_bf16 v[96:111], v[24:27], v[48:51], v[96:111]
  ds_read_b64_tr_b16 v[42:43], v14 offset:46080
  ds_read_b64_tr_b16 v[44:45], v15 offset:45056
  ds_read_b64_tr_b16 v[46:47], v15 offset:46080
  s_waitcnt lgkmcnt(9)
  v_mfma_f32_32x32x16_bf16 v[112:127], v[28:31], v[48:51], v[112:127]
  s_waitcnt lgkmcnt(6)
  v_mfma_f32_32x32x16_bf16 v[64:79], v[32:35], v[52:55], v[64:79]
  s_waitcnt lgkmcnt(4)
  v_mfma_f32_32x32x16_bf16 v[80:95], v[36:39], v[52:55], v[80:95]
  s_waitcnt lgkmcnt(2)
  v_mfma_f32_32x32x16_bf16 v[96:111], v[40:43], v[52:55], v[96:111]
  s_waitcnt lgkmcnt(0)
  s_cmp_lg_u32 s43, 2
  s_cbranch_scc1 L_bx_c_2
  s_barrier
L_bx_c_2:
  s_barrier
  ds_read_b128 v[48:51], v8 offset:0
  ds_read_b64_tr_b16 v[16:17], v248 offset:0
  ds_read_b64_tr_b16 v[18:19], v248 offset:1024
  ds_read_b64_tr_b16 v[20:21], v249 offset:0
  ds_read_b64_tr_b16 v[22:23], v249 offset:1024
  v_mfma_f32_32x32x16_bf16 v[112:127], v[44:47], v[52:55], v[112:127]
  ds_read_b64_tr_b16 v[24:25], v250 offset:0
  ds_read_b64_tr_b16 v[26:27], v250 offset:1024
  ds_read_b64_tr_b16 v[28:29], v251 offset:0
  ds_read_b64_tr_b16 v[30:31], v251 offset:1024
  s_waitcnt lgkmcnt(6)
  v_mfma_f32_32x32x16_bf16 v[64:79], v[16:19], v[48:51], v[64:79]
  ds_read_b128 v[52:55], v9 offset:0
  ds_read_b64_tr_b16 v[32:33], v248 offset:4096
  ds_read_b64_tr_b16 v[34:35], v248 offset:5120
  s_waitcnt lgkmcnt(7)
  v_mfma_f32_32x32x16_bf16 v[80:95], v[20:23], v[48:51], v[80:95]
  ds_read_b64_tr_b16 v[36:37], v249 offset:4096
  ds_read_b64_tr_b16 v[38:39], v249 offset:5120
  ds_read_b64_tr_b16 v[40:41], v250 offset:4096
  s_waitcnt lgkmcnt(8)
  v_mfma_f32_32x32x16_bf16 v[96:111], v[24:27], v[48:51], v[96:111]
  ds_read_b64_tr_b16 v[42:43], v250 offset:5120
  ds_read_b64_tr_b16 v[44:45], v251 offset:4096
  ds_read_b64_tr_b16 v[46:47], v251 offset:5120
  s_waitcnt lgkmcnt(9)
  v_mfma_f32_32x32x16_bf16 v[112:127], v[28:31], v[48:51], v[112:127]
  s_waitcnt lgkmcnt(6)
  v_mfma_f32_32x32x16_bf16 v[64:79], v[32:35], v[52:55], v[64:79]
  ds_read_b128 v[48:51], v10 offset:0
  ds_read_b64_tr_b16 v[16:17], v248 offset:8192
  ds_read_b64_tr_b16 v[18:19], v248 offset:9216
  s_waitcnt lgkmcnt(7)
  v_mfma_f32_32x32x16_bf16 v[80:95], v[36:39], v[52:55], v[80:95]
  ds_read_b64_tr_b16 v[20:21], v249 offset:8192
  ds_read_b64_tr_b16 v[22:23], v249 offset:9216
  ds_read_b64_tr_b16 v[24:25], v250 offset:8192
  s_waitcnt lgkmcnt(8)
  v_mfma_f32_32x32x16_bf16 v[96:111], v[40:43], v[52:55], v[96:111]
  ds_read_b64_tr_b16 v[26:27], v250 offset:9216
  ds_read_b64_tr_b16 v[28:29], v251 offset:8192
  ds_read_b64_tr_b16 v[30:31], v251 offset:9216
  s_waitcnt lgkmcnt(9)
  v_mfma_f32_32x32x16_bf16 v[112:127], v[44:47], v[52:55], v[112:127]
  s_waitcnt lgkmcnt(6)
  v_mfma_f32_32x32x16_bf16 v[64:79], v[16:19], v[48:51], v[64:79]
  ds_read_b128 v[52:55], v11 offset:0
  ds_read_b64_tr_b16 v[32:33], v248 offset:12288
  ds_read_b64_tr_b16 v[34:35], v248 offset:13312
  s_waitcnt lgkmcnt(7)
  v_mfma_f32_32x32x16_bf16 v[80:95], v[20:23], v[48:51], v[80:95]
  ds_read_b64_tr_b16 v[36:37], v249 offset:12288
  ds_read_b64_tr_b16 v[38:39], v249 offset:13312
  ds_read_b64_tr_b16 v[40:41], v250 offset:12288
  s_waitcnt lgkmcnt(8)
  v_mfma_f32_32x32x16_bf16 v[96:111], v[24:27], v[48:51], v[96:111]
  ds_read_b64_tr_b16 v[42:43], v250 offset:13312
  ds_read_b64_tr_b16 v[44:45], v251 offset:12288
  ds_read_b64_tr_b16 v[46:47], v251 offset:13312
  s_waitcnt lgkmcnt(9)
  v_mfma_f32_32x32x16_bf16 v[112:127], v[28:31], v[48:51], v[112:127]
  s_waitcnt lgkmcnt(6)
  v_mfma_f32_32x32x16_bf16 v[64:79], v[32:35], v[52:55], v[64:79]
  s_waitcnt lgkmcnt(4)
  v_mfma_f32_32x32x16_bf16 v[80:95], v[36:39], v[52:55], v[80:95]
  s_waitcnt lgkmcnt(2)
  v_mfma_f32_32x32x16_bf16 v[96:111], v[40:43], v[52:55], v[96:111]
  s_waitcnt lgkmcnt(0)
  s_cmp_lg_u32 s43, 3
  s_cbranch_scc1 L_bx_c_3
  s_barrier
L_bx_c_3:
  s_barrier
  ds_read_b128 v[48:51], v4 offset:0
  ds_read_b64_tr_b16 v[16:17], v12 offset:0
  ds_read_b64_tr_b16 v[18:19], v12 offset:1024
  ds_read_b64_tr_b16 v[20:21], v13 offset:0
  ds_read_b64_tr_b16 v[22:23], v13 offset:1024
  v_mfma_f32_32x32x16_bf16 v[112:127], v[44:47], v[52:55], v[112:127]
  ds_read_b64_tr_b16 v[24:25], v14 offset:0
  ds_read_b64_tr_b16 v[26:27], v14 offset:1024
  ds_read_b64_tr_b16 v[28:29], v15 offset:0
  ds_read_b64_tr_b16 v[30:31], v15 offset:1024
  s_waitcnt lgkmcnt(6)
  v_mfma_f32_32x32x16_bf16 v[64:79], v[16:19], v[48:51], v[64:79]
  ds_read_b128 v[52:55], v5 offset:0
  ds_read_b64_tr_b16 v[32:33], v12 offset:4096
  ds_read_b64_tr_b16 v[34:35], v12 offset:5120
  s_waitcnt lgkmcnt(7)
  v_mfma_f32_32x32x16_bf16 v[80:95], v[20:23], v[48:51], v[80:95]
  ds_read_b64_tr_b16 v[36:37], v13 offset:4096
  ds_read_b64_tr_b16 v[38:39], v13 offset:5120
  ds_read_b64_tr_b16 v[40:41], v14 offset:4096
  s_waitcnt lgkmcnt(8)
  v_mfma_f32_32x32x16_bf16 v[96:111], v[24:27], v[48:51], v[96:111]
  ds_read_b64_tr_b16 v[42:43], v14 offset:5120
  ds_read_b64_tr_b16 v[44:45], v15 offset:4096
  ds_read_b64_tr_b16 v[46:47], v15 offset:5120
  s_waitcnt lgkmcnt(9)
  v_mfma_f32_32x32x16_bf16 v[112:127], v[28:31], v[48:51], v[112:127]
  s_waitcnt lgkmcnt(6)
  v_mfma_f32_32x32x16_bf16 v[64:79], v[32:35], v[52:55], v[64:79]
  ds_read_b128 v[48:51], v6 offset:0
  ds_read_b64_tr_b16 v[16:17], v12 offset:8192
  ds_read_b64_tr_b16 v[18:19], v12 offset:9216
  s_waitcnt lgkmcnt(7)
  v_mfma_f32_32x32x16_bf16 v[80:95], v[36:39], v[52:55], v[80:95]
  ds_read_b64_tr_b16 v[20:21], v13 offset:8192
  ds_read_b64_tr_b16 v[22:23], v13 offset:9216
  ds_read_b64_tr_b16 v[24:25], v14 offset:8192
  s_waitcnt lgkmcnt(8)
  v_mfma_f32_32x32x16_bf16 v[96:111], v[40:43], v[52:55], v[96:111]
  ds_read_b64_tr_b16 v[26:27], v14 offset:9216
  ds_read_b64_tr_b16 v[28:29], v15 offset:8192
  ds_read_b64_tr_b16 v[30:31], v15 offset:9216
  s_waitcnt lgkmcnt(9)
  v_mfma_f32_32x32x16_bf16 v[112:127], v[44:47], v[52:55], v[112:127]
  s_waitcnt lgkmcnt(6)
  v_mfma_f32_32x32x16_bf16 v[64:79], v[16:19], v[48:51], v[64:79]
  ds_read_b128 v[52:55], v7 offset:0
  ds_read_b64_tr_b16 v[32:33], v12 offset:12288
  ds_read_b64_tr_b16 v[34:35], v12 offset:13312
  s_waitcnt lgkmcnt(7)
  v_mfma_f32_32x32x16_bf16 v[80:95], v[20:23], v[48:51], v[80:95]
  ds_read_b64_tr_b16 v[36:37], v13 offset:12288
  ds_read_b64_tr_b16 v[38:39], v13 offset:13312
  ds_read_b64_tr_b16 v[40:41], v14 offset:12288
  s_waitcnt lgkmcnt(8)
  v_mfma_f32_32x32x16_bf16 v[96:111], v[24:27], v[48:51], v[96:111]
  ds_read_b64_tr_b16 v[42:43], v14 offset:13312
  ds_read_b64_tr_b16 v[44:45], v15 offset:12288
  ds_read_b64_tr_b16 v[46:47], v15 offset:13312
  s_waitcnt lgkmcnt(9)
  v_mfma_f32_32x32x16_bf16 v[112:127], v[28:31], v[48:51], v[112:127]
  s_waitcnt lgkmcnt(6)
  v_mfma_f32_32x32x16_bf16 v[64:79], v[32:35], v[52:55], v[64:79]
  s_waitcnt lgkmcnt(4)
  v_mfma_f32_32x32x16_bf16 v[80:95], v[36:39], v[52:55], v[80:95]
  s_waitcnt lgkmcnt(2)
  v_mfma_f32_32x32x16_bf16 v[96:111], v[40:43], v[52:55], v[96:111]
  s_waitcnt lgkmcnt(0)
  s_cmp_lg_u32 s43, 4
  s_cbranch_scc1 L_bx_c_4
  s_barrier
L_bx_c_4:
  s_barrier
  ds_read_b128 v[48:51], v4 offset:32768
  ds_read_b64_tr_b16 v[16:17], v12 offset:32768
  ds_read_b64_tr_b16 v[18:19], v12 offset:33792
  ds_read_b64_tr_b16 v[20:21], v13 offset:32768
  ds_read_b64_tr_b16 v[22:23], v13 offset:33792
  v_mfma_f32_32x32x16_bf16 v[112:127], v[44:47], v[52:55], v[112:127]
  ds_read_b64_tr_b16 v[24:25], v14 offset:32768
  ds_read_b64_tr_b16 v[26:27], v14 offset:33792
  ds_read_b64_tr_b16 v[28:29], v15 offset:32768
  ds_read_b64_tr_b16 v[30:31], v15 offset:33792
  s_waitcnt lgkmcnt(6)
  v_mfma_f32_32x32x16_bf16 v[64:79], v[16:19], v[48:51], v[64:79]
  ds_read_b128 v[52:55], v5 offset:32768
  ds_read_b64_tr_b16 v[32:33], v12 offset:36864
  ds_read_b64_tr_b16 v[34:35], v12 offset:37888
  s_waitcnt lgkmcnt(7)
  v_mfma_f32_32x32x16_bf16 v[80:95], v[20:23], v[48:51], v[80:95]
  ds_read_b64_tr_b16 v[36:37], v13 offset:36864
  ds_read_b64_tr_b16 v[38:39], v13 offset:37888
  ds_read_b64_tr_b16 v[40:41], v14 offset:36864
  s_waitcnt lgkmcnt(8)
  v_mfma_f32_32x32x16_bf16 v[96:111], v[24:27], v[48:51], v[96:111]
  ds_read_b64_tr_b16 v[42:43], v14 offset:37888
  ds_read_b64_tr_b16 v[44:45], v15 offset:36864
  ds_read_b64_tr_b16 v[46:47], v15 offset:37888
  s_waitcnt lgkmcnt(9)
  v_mfma_f32_32x32x16_bf16 v[112:127], v[28:31], v[48:51], v[112:127]
  s_waitcnt lgkmcnt(6)
  v_mfma_f32_32x32x16_bf16 v[64:79], v[32:35], v[52:55], v[64:79]
  ds_read_b128 v[48:51], v6 offset:32768
  ds_read_b64_tr_b16 v[16:17], v12 offset:40960
  ds_read_b64_tr_b16 v[18:19], v12 offset:41984
  s_waitcnt lgkmcnt(7)
  v_mfma_f32_32x32x16_bf16 v[80:95], v[36:39], v[52:55], v[80:95]
  ds_read_b64_tr_b16 v[20:21], v13 offset:40960
  ds_read_b64_tr_b16 v[22:23], v13 offset:41984
  ds_read_b64_tr_b16 v[24:25], v14 offset:40960
  s_waitcnt lgkmcnt(8)
  v_mfma_f32_32x32x16_bf16 v[96:111], v[40:43], v[52:55], v[96:111]
  ds_read_b64_tr_b16 v[26:27], v14 offset:41984
  ds_read_b64_tr_b16 v[28:29], v15 offset:40960
  ds_read_b64_tr_b16 v[30:31], v15 offset:41984
  s_waitcnt lgkmcnt(9)
  v_mfma_f32_32x32x16_bf16 v[112:127], v[44:47], v[52:55], v[112:127]
  s_waitcnt lgkmcnt(6)
  v_mfma_f32_32x32x16_bf16 v[64:79], v[16:19], v[48:51], v[64:79]
  ds_read_b128 v[52:55], v7 offset:32768
  ds_read_b64_tr_b16 v[32:33], v12 offset:45056
  ds_read_b64_tr_b16 v[34:35], v12 offset:46080
  s_waitcnt lgkmcnt(7)
  v_mfma_f32_32x32x16_bf16 v[80:95], v[20:23], v[48:51], v[80:95]
  ds_read_b64_tr_b16 v[36:37], v13 offset:45056
  ds_read_b64_tr_b16 v[38:39], v13 offset:46080
  ds_read_b64_tr_b16 v[40:41], v14 offset:45056
  s_waitcnt lgkmcnt(8)
  v_mfma_f32_32x32x16_bf16 v[96:111], v[24:27], v[48:51], v[96:111]
  ds_read_b64_tr_b16 v[42:43], v14 offset:46080
  ds_read_b64_tr_b16 v[44:45], v15 offset:45056
  ds_read_b64_tr_b16 v[46:47], v15 offset:46080
  s_waitcnt lgkmcnt(9)
  v_mfma_f32_32x32x16_bf16 v[112:127], v[28:31], v[48:51], v[112:127]
  s_waitcnt lgkmcnt(6)
  v_mfma_f32_32x32x16_bf16 v[64:79], v[32:35], v[52:55], v[64:79]
  s_waitcnt lgkmcnt(4)
  v_mfma_f32_32x32x16_bf16 v[80:95], v[36:39], v[52:55], v[80:95]
  s_waitcnt lgkmcnt(2)
  v_mfma_f32_32x32x16_bf16 v[96:111], v[40:43], v[52:55], v[96:111]
  s_waitcnt lgkmcnt(0)
  s_cmp_lg_u32 s43, 5
  s_cbranch_scc1 L_bx_c_5
  s_barrier
L_bx_c_5:
  s_barrier
  ds_read_b128 v[48:51], v8 offset:0
  ds_read_b64_tr_b16 v[16:17], v248 offset:0
  ds_read_b64_tr_b16 v[18:19], v248 offset:1024
  ds_read_b64_tr_b16 v[20:21], v249 offset:0
  ds_read_b64_tr_b16 v[22:23], v249 offset:1024
  v_mfma_f32_32x32x16_bf16 v[112:127], v[44:47], v[52:55], v[112:127]
  ds_read_b64_tr_b16 v[24:25], v250 offset:0
  ds_read_b64_tr_b16 v[26:27], v250 offset:1024
  ds_read_b64_tr_b16 v[28:29], v251 offset:0
  ds_read_b64_tr_b16 v[30:31], v251 offset:1024
  s_waitcnt lgkmcnt(6)
  v_mfma_f32_32x32x16_bf16 v[64:79], v[16:19], v[48:51], v[64:79]
  ds_read_b128 v[52:55], v9 offset:0
  ds_read_b64_tr_b16 v[32:33], v248 offset:4096
  ds_read_b64_tr_b16 v[34:35], v248 offset:5120
  s_waitcnt lgkmcnt(7)
  v_mfma_f32_32x32x16_bf16 v[80:95], v[20:23], v[48:51], v[80:95]
  ds_read_b64_tr_b16 v[36:37], v249 offset:4096
  ds_read_b64_tr_b16 v[38:39], v249 offset:5120
  ds_read_b64_tr_b16 v[40:41], v250 offset:4096
  s_waitcnt lgkmcnt(8)
  v_mfma_f32_32x32x16_bf16 v[96:111], v[24:27], v[48:51], v[96:111]
  ds_read_b64_tr_b16 v[42:43], v250 offset:5120
  ds_read_b64_tr_b16 v[44:45], v251 offset:4096
  ds_read_b64_tr_b16 v[46:47], v251 offset:5120
  s_waitcnt lgkmcnt(9)
  v_mfma_f32_32x32x16_bf16 v[112:127], v[28:31], v[48:51], v[112:127]
  s_waitcnt lgkmcnt(6)
  v_mfma_f32_32x32x16_bf16 v[64:79], v[32:35], v[52:55], v[64:79]
  ds_read_b128 v[48:51], v10 offset:0
  ds_read_b64_tr_b16 v[16:17], v248 offset:8192
  ds_read_b64_tr_b16 v[18:19], v248 offset:9216
  s_waitcnt lgkmcnt(7)
  v_mfma_f32_32x32x16_bf16 v[80:95], v[36:39], v[52:55], v[80:95]
  ds_read_b64_tr_b16 v[20:21], v249 offset:8192
  ds_read_b64_tr_b16 v[22:23], v249 offset:9216
  ds_read_b64_tr_b16 v[24:25], v250 offset:8192
  s_waitcnt lgkmcnt(8)
  v_mfma_f32_32x32x16_bf16 v[96:111], v[40:43], v[52:55], v[96:111]
  ds_read_b64_tr_b16 v[26:27], v250 offset:9216
  ds_read_b64_tr_b16 v[28:29], v251 offset:8192
  ds_read_b64_tr_b16 v[30:31], v251 offset:9216
  s_waitcnt lgkmcnt(9)
  v_mfma_f32_32x32x16_bf16 v[112:127], v[44:47], v[52:55], v[112:127]
  s_waitcnt lgkmcnt(6)
  v_mfma_f32_32x32x16_bf16 v[64:79], v[16:19], v[48:51], v[64:79]
  ds_read_b128 v[52:55], v11 offset:0
  ds_read_b64_tr_b16 v[32:33], v248 offset:12288
  ds_read_b64_tr_b16 v[34:35], v248 offset:13312
  s_waitcnt lgkmcnt(7)
  v_mfma_f32_32x32x16_bf16 v[80:95], v[20:23], v[48:51], v[80:95]
  ds_read_b64_tr_b16 v[36:37], v249 offset:12288
  ds_read_b64_tr_b16 v[38:39], v249 offset:13312
  ds_read_b64_tr_b16 v[40:41], v250 offset:12288
  s_waitcnt lgkmcnt(8)
  v_mfma_f32_32x32x16_bf16 v[96:111], v[24:27], v[48:51], v[96:111]
  ds_read_b64_tr_b16 v[42:43], v250 offset:13312
  ds_read_b64_tr_b16 v[44:45], v251 offset:12288
  ds_read_b64_tr_b16 v[46:47], v251 offset:13312
  s_waitcnt lgkmcnt(9)
  v_mfma_f32_32x32x16_bf16 v[112:127], v[28:31], v[48:51], v[112:127]
  s_waitcnt lgkmcnt(6)
  v_mfma_f32_32x32x16_bf16 v[64:79], v[32:35], v[52:55], v[64:79]
  s_waitcnt lgkmcnt(4)
  v_mfma_f32_32x32x16_bf16 v[80:95], v[36:39], v[52:55], v[80:95]
  s_waitcnt lgkmcnt(2)
  v_mfma_f32_32x32x16_bf16 v[96:111], v[40:43], v[52:55], v[96:111]
  s_waitcnt lgkmcnt(0)
  s_cmp_lg_u32 s43, 6
  s_cbranch_scc1 L_bx_c_6
  s_barrier
L_bx_c_6:
  s_barrier
  ds_read_b128 v[48:51], v4 offset:0
  ds_read_b64_tr_b16 v[16:17], v12 offset:0
  ds_read_b64_tr_b16 v[18:19], v12 offset:1024
  ds_read_b64_tr_b16 v[20:21], v13 offset:0
  ds_read_b64_tr_b16 v[22:23], v13 offset:1024
  v_mfma_f32_32x32x16_bf16 v[112:127], v[44:47], v[52:55], v[112:127]
  ds_read_b64_tr_b16 v[24:25], v14 offset:0
  ds_read_b64_tr_b16 v[26:27], v14 offset:1024
  ds_read_b64_tr_b16 v[28:29], v15 offset:0
  ds_read_b64_tr_b16 v[30:31], v15 offset:1024
  s_waitcnt lgkmcnt(6)
  v_mfma_f32_32x32x16_bf16 v[64:79], v[16:19], v[48:51], v[64:79]
  ds_read_b128 v[52:55], v5 offset:0
  ds_read_b64_tr_b16 v[32:33], v12 offset:4096
  ds_read_b64_tr_b16 v[34:35], v12 offset:5120
  s_waitcnt lgkmcnt(7)
  v_mfma_f32_32x32x16_bf16 v[80:95], v[20:23], v[48:51], v[80:95]
  ds_read_b64_tr_b16 v[36:37], v13 offset:4096
  ds_read_b64_tr_b16 v[38:39], v13 offset:5120
  ds_read_b64_tr_b16 v[40:41], v14 offset:4096
  s_waitcnt lgkmcnt(8)
  v_mfma_f32_32x32x16_bf16 v[96:111], v[24:27], v[48:51], v[96:111]
  ds_read_b64_tr_b16 v[42:43], v14 offset:5120
  ds_read_b64_tr_b16 v[44:45], v15 offset:4096
  ds_read_b64_tr_b16 v[46:47], v15 offset:5120
  s_waitcnt lgkmcnt(9)
  v_mfma_f32_32x32x16_bf16 v[112:127], v[28:31], v[48:51], v[112:127]
  buffer_load_dwordx2 v[62:63], v1, s[36:39], 0 offen sc1
  buffer_load_dword v61, v1, s[36:39], s40 offen sc1
  buffer_load_dword v2, v1, s[44:47], s42 offen sc1
  s_waitcnt lgkmcnt(6)
  v_mfma_f32_32x32x16_bf16 v[64:79], v[32:35], v[52:55], v[64:79]
  ds_read_b128 v[48:51], v6 offset:0
  ds_read_b64_tr_b16 v[16:17], v12 offset:8192
  ds_read_b64_tr_b16 v[18:19], v12 offset:9216
  s_waitcnt lgkmcnt(7)
  v_mfma_f32_32x32x16_bf16 v[80:95], v[36:39], v[52:55], v[80:95]
  ds_read_b64_tr_b16 v[20:21], v13 offset:8192
  ds_read_b64_tr_b16 v[22:23], v13 offset:9216
  ds_read_b64_tr_b16 v[24:25], v14 offset:8192
  s_waitcnt lgkmcnt(8)
  v_mfma_f32_32x32x16_bf16 v[96:111], v[40:43], v[52:55], v[96:111]
  ds_read_b64_tr_b16 v[26:27], v14 offset:9216
  ds_read_b64_tr_b16 v[28:29], v15 offset:8192
  ds_read_b64_tr_b16 v[30:31], v15 offset:9216
  s_waitcnt lgkmcnt(9)
  v_mfma_f32_32x32x16_bf16 v[112:127], v[44:47], v[52:55], v[112:127]
  s_waitcnt lgkmcnt(6)
  v_mfma_f32_32x32x16_bf16 v[64:79], v[16:19], v[48:51], v[64:79]
  ds_read_b128 v[52:55], v7 offset:0
  ds_read_b64_tr_b16 v[32:33], v12 offset:12288
  ds_read_b64_tr_b16 v[34:35], v12 offset:13312
  s_waitcnt lgkmcnt(7)
  v_mfma_f32_32x32x16_bf16 v[80:95], v[20:23], v[48:51], v[80:95]
  ds_read_b64_tr_b16 v[36:37], v13 offset:12288
  ds_read_b64_tr_b16 v[38:39], v13 offset:13312
  ds_read_b64_tr_b16 v[40:41], v14 offset:12288
  s_waitcnt lgkmcnt(8)
  v_mfma_f32_32x32x16_bf16 v[96:111], v[24:27], v[48:51], v[96:111]
  ds_read_b64_tr_b16 v[42:43], v14 offset:13312
  ds_read_b64_tr_b16 v[44:45], v15 offset:12288
  ds_read_b64_tr_b16 v[46:47], v15 offset:13312
  s_waitcnt lgkmcnt(9)
  v_mfma_f32_32x32x16_bf16 v[112:127], v[28:31], v[48:51], v[112:127]
  s_waitcnt lgkmcnt(6)
  v_mfma_f32_32x32x16_bf16 v[64:79], v[32:35], v[52:55], v[64:79]
  s_waitcnt lgkmcnt(4)
  v_mfma_f32_32x32x16_bf16 v[80:95], v[36:39], v[52:55], v[80:95]
  s_waitcnt lgkmcnt(2)
  v_mfma_f32_32x32x16_bf16 v[96:111], v[40:43], v[52:55], v[96:111]
  s_waitcnt lgkmcnt(0)
  s_barrier
  ds_read_b128 v[48:51], v4 offset:32768
  ds_read_b64_tr_b16 v[16:17], v12 offset:32768
  ds_read_b64_tr_b16 v[18:19], v12 offset:33792
  ds_read_b64_tr_b16 v[20:21], v13 offset:32768
  ds_read_b64_tr_b16 v[22:23], v13 offset:33792
  v_mfma_f32_32x32x16_bf16 v[112:127], v[44:47], v[52:55], v[112:127]
  ds_read_b64_tr_b16 v[24:25], v14 offset:32768
  ds_read_b64_tr_b16 v[26:27], v14 offset:33792
  ds_read_b64_tr_b16 v[28:29], v15 offset:32768
  ds_read_b64_tr_b16 v[30:31], v15 offset:33792
  s_waitcnt lgkmcnt(6)
  v_mfma_f32_32x32x16_bf16 v[64:79], v[16:19], v[48:51], v[64:79]
  ds_read_b128 v[52:55], v5 offset:32768
  ds_read_b64_tr_b16 v[32:33], v12 offset:36864
  ds_read_b64_tr_b16 v[34:35], v12 offset:37888
  s_waitcnt lgkmcnt(7)
  v_mfma_f32_32x32x16_bf16 v[80:95], v[20:23], v[48:51], v[80:95]
  ds_read_b64_tr_b16 v[36:37], v13 offset:36864
  ds_read_b64_tr_b16 v[38:39], v13 offset:37888
  ds_read_b64_tr_b16 v[40:41], v14 offset:36864
  s_waitcnt lgkmcnt(8)
  v_mfma_f32_32x32x16_bf16 v[96:111], v[24:27], v[48:51], v[96:111]
  ds_read_b64_tr_b16 v[42:43], v14 offset:37888
  ds_read_b64_tr_b16 v[44:45], v15 offset:36864
  ds_read_b64_tr_b16 v[46:47], v15 offset:37888
  s_waitcnt lgkmcnt(9)
  v_mfma_f32_32x32x16_bf16 v[112:127], v[28:31], v[48:51], v[112:127]
  s_waitcnt lgkmcnt(6)
  v_mfma_f32_32x32x16_bf16 v[64:79], v[32:35], v[52:55], v[64:79]
  ds_read_b128 v[48:51], v6 offset:32768
  ds_read_b64_tr_b16 v[16:17], v12 offset:40960
  ds_read_b64_tr_b16 v[18:19], v12 offset:41984
  s_waitcnt lgkmcnt(7)
  v_mfma_f32_32x32x16_bf16 v[80:95], v[36:39], v[52:55], v[80:95]
  ds_read_b64_tr_b16 v[20:21], v13 offset:40960
  ds_read_b64_tr_b16 v[22:23], v13 offset:41984
  ds_read_b64_tr_b16 v[24:25], v14 offset:40960
  s_waitcnt lgkmcnt(8)
  v_mfma_f32_32x32x16_bf16 v[96:111], v[40:43], v[52:55], v[96:111]
  ds_read_b64_tr_b16 v[26:27], v14 offset:41984
  ds_read_b64_tr_b16 v[28:29], v15 offset:40960
  ds_read_b64_tr_b16 v[30:31], v15 offset:41984
  s_waitcnt lgkmcnt(9)
  v_mfma_f32_32x32x16_bf16 v[112:127], v[44:47], v[52:55], v[112:127]
  s_waitcnt lgkmcnt(6)
  v_mfma_f32_32x32x16_bf16 v[64:79], v[16:19], v[48:51], v[64:79]
  ds_read_b128 v[52:55], v7 offset:32768
  ds_read_b64_tr_b16 v[32:33], v12 offset:45056
  ds_read_b64_tr_b16 v[34:35], v12 offset:46080
  s_waitcnt lgkmcnt(7)
  v_mfma_f32_32x32x16_bf16 v[80:95], v[20:23], v[48:51], v[80:95]
  ds_read_b64_tr_b16 v[36:37], v13 offset:45056
  ds_read_b64_tr_b16 v[38:39], v13 offset:46080
  ds_read_b64_tr_b16 v[40:41], v14 offset:45056
  s_waitcnt lgkmcnt(8)
  v_mfma_f32_32x32x16_bf16 v[96:111], v[24:27], v[48:51], v[96:111]
  ds_read_b64_tr_b16 v[42:43], v14 offset:46080
  ds_read_b64_tr_b16 v[44:45], v15 offset:45056
  ds_read_b64_tr_b16 v[46:47], v15 offset:46080
  s_waitcnt lgkmcnt(9)
  v_mfma_f32_32x32x16_bf16 v[112:127], v[28:31], v[48:51], v[112:127]
  s_waitcnt lgkmcnt(6)
  v_mfma_f32_32x32x16_bf16 v[64:79], v[32:35], v[52:55], v[64:79]
  s_waitcnt lgkmcnt(4)
  v_mfma_f32_32x32x16_bf16 v[80:95], v[36:39], v[52:55], v[80:95]
  s_waitcnt lgkmcnt(2)
  v_mfma_f32_32x32x16_bf16 v[96:111], v[40:43], v[52:55], v[96:111]
  s_waitcnt lgkmcnt(0)
  s_barrier
  ds_read_b128 v[48:51], v8 offset:0
  ds_read_b64_tr_b16 v[16:17], v248 offset:0
  ds_read_b64_tr_b16 v[18:19], v248 offset:1024
  ds_read_b64_tr_b16 v[20:21], v249 offset:0
  ds_read_b64_tr_b16 v[22:23], v249 offset:1024
  v_mfma_f32_32x32x16_bf16 v[112:127], v[44:47], v[52:55], v[112:127]
  ds_read_b64_tr_b16 v[24:25], v250 offset:0
  ds_read_b64_tr_b16 v[26:27], v250 offset:1024
  ds_read_b64_tr_b16 v[28:29], v251 offset:0
  ds_read_b64_tr_b16 v[30:31], v251 offset:1024
  s_waitcnt lgkmcnt(6)
  v_mfma_f32_32x32x16_bf16 v[64:79], v[16:19], v[48:51], v[64:79]
  ds_read_b128 v[52:55], v9 offset:0
  ds_read_b64_tr_b16 v[32:33], v248 offset:4096
  ds_read_b64_tr_b16 v[34:35], v248 offset:5120
  s_waitcnt lgkmcnt(7)
  v_mfma_f32_32x32x16_bf16 v[80:95], v[20:23], v[48:51], v[80:95]
  ds_read_b64_tr_b16 v[36:37], v249 offset:4096
  ds_read_b64_tr_b16 v[38:39], v249 offset:5120
  ds_read_b64_tr_b16 v[40:41], v250 offset:4096
  s_waitcnt lgkmcnt(8)
  v_mfma_f32_32x32x16_bf16 v[96:111], v[24:27], v[48:51], v[96:111]
  ds_read_b64_tr_b16 v[42:43], v250 offset:5120
  ds_read_b64_tr_b16 v[44:45], v251 offset:4096
  ds_read_b64_tr_b16 v[46:47], v251 offset:5120
  s_waitcnt lgkmcnt(9)
  v_mfma_f32_32x32x16_bf16 v[112:127], v[28:31], v[48:51], v[112:127]
  s_waitcnt lgkmcnt(6)
  v_mfma_f32_32x32x16_bf16 v[64:79], v[32:35], v[52:55], v[64:79]
  ds_read_b128 v[48:51], v10 offset:0
  ds_read_b64_tr_b16 v[16:17], v248 offset:8192
  ds_read_b64_tr_b16 v[18:19], v248 offset:9216
  s_waitcnt lgkmcnt(7)
  v_mfma_f32_32x32x16_bf16 v[80:95], v[36:39], v[52:55], v[80:95]
  ds_read_b64_tr_b16 v[20:21], v249 offset:8192
  ds_read_b64_tr_b16 v[22:23], v249 offset:9216
  ds_read_b64_tr_b16 v[24:25], v250 offset:8192
  s_waitcnt lgkmcnt(8)
  v_mfma_f32_32x32x16_bf16 v[96:111], v[40:43], v[52:55], v[96:111]
  ds_read_b64_tr_b16 v[26:27], v250 offset:9216
  ds_read_b64_tr_b16 v[28:29], v251 offset:8192
  ds_read_b64_tr_b16 v[30:31], v251 offset:9216
  s_waitcnt lgkmcnt(9)
  v_mfma_f32_32x32x16_bf16 v[112:127], v[44:47], v[52:55], v[112:127]
  s_waitcnt vmcnt(0)
  v_mov_b32 v9, 0
  s_mov_b32 s50, 0
L_nonce_chk:
  v_readfirstlane_b32 s52, v62
  v_readfirstlane_b32 s53, v63
  s_nop 0
  s_cmp_lg_u32 s52, 0
  s_cbranch_scc1 L_nonce_ok
  buffer_load_dwordx2 v[62:63], v9, s[36:39], 0 offen sc1
  s_add_u32 s50, s50, 1
  s_waitcnt vmcnt(0)
  s_cmp_lt_u32 s50, 200000
  s_cbranch_scc1 L_nonce_chk
L_nonce_ok:
  s_mov_b32 s54, 0
  v_readfirstlane_b32 s55, v61
  s_and_b32 s56, s4, 1
  s_lshl_b32 s56, s56, 4
  s_lshr_b32 s55, s55, s56
  s_and_b32 s56, s55, 31
  s_bfe_u32 s57, s55, 0x80005
  s_bfe_u32 s55, s55, 0x3000d
  s_mul_i32 s56, s56, s56
  s_lshl_b32 s57, s57, 2
  s_cmp_eq_u32 s56, s57
  s_cselect_b32 s54, 1, 0
  s_cmp_eq_u32 s55, 4
  s_cselect_b32 s54, s54, 0
  s_waitcnt lgkmcnt(6)
  v_mfma_f32_32x32x16_bf16 v[64:79], v[16:19], v[48:51], v[64:79]
  ds_read_b128 v[52:55], v11 offset:0
  ds_read_b64_tr_b16 v[32:33], v248 offset:12288
  ds_read_b64_tr_b16 v[34:35], v248 offset:13312
  s_waitcnt lgkmcnt(7)
  v_mfma_f32_32x32x16_bf16 v[80:95], v[20:23], v[48:51], v[80:95]
  ds_read_b64_tr_b16 v[36:37], v249 offset:12288
  ds_read_b64_tr_b16 v[38:39], v249 offset:13312
  ds_read_b64_tr_b16 v[40:41], v250 offset:12288
  s_waitcnt lgkmcnt(8)
  v_mfma_f32_32x32x16_bf16 v[96:111], v[24:27], v[48:51], v[96:111]
  ds_read_b64_tr_b16 v[42:43], v250 offset:13312
  ds_read_b64_tr_b16 v[44:45], v251 offset:12288
  ds_read_b64_tr_b16 v[46:47], v251 offset:13312
  s_waitcnt lgkmcnt(9)
  v_mfma_f32_32x32x16_bf16 v[112:127], v[28:31], v[48:51], v[112:127]
  s_waitcnt lgkmcnt(6)
  v_mfma_f32_32x32x16_bf16 v[64:79], v[32:35], v[52:55], v[64:79]
  s_waitcnt lgkmcnt(4)
  v_mfma_f32_32x32x16_bf16 v[80:95], v[36:39], v[52:55], v[80:95]
  s_waitcnt lgkmcnt(2)
  v_mfma_f32_32x32x16_bf16 v[96:111], v[40:43], v[52:55], v[96:111]
  s_waitcnt lgkmcnt(0)
  v_mfma_f32_32x32x16_bf16 v[112:127], v[44:47], v[52:55], v[112:127]
  s_barrier
  ds_read_b128 v[160:163], v56 offset:0
  ds_read_b128 v[164:167], v57 offset:0
  ds_read_b128 v[168:171], v58 offset:0
  ds_read_b128 v[172:175], v59 offset:0
  ds_read_b128 v[176:179], v56 offset:1024
  ds_read_b128 v[180:183], v57 offset:1024
  ds_read_b128 v[184:187], v58 offset:1024
  ds_read_b128 v[188:191], v59 offset:1024
  v_cvt_pk_bf16_f32 v128, v64, v65
  v_cvt_pk_bf16_f32 v129, v66, v67
  v_cvt_pk_bf16_f32 v130, v68, v69
  v_cvt_pk_bf16_f32 v131, v70, v71
  v_cvt_pk_bf16_f32 v132, v72, v73
  v_cvt_pk_bf16_f32 v133, v74, v75
  v_cvt_pk_bf16_f32 v134, v76, v77
  v_cvt_pk_bf16_f32 v135, v78, v79
  v_cvt_pk_bf16_f32 v136, v80, v81
  v_cvt_pk_bf16_f32 v137, v82, v83
  v_cvt_pk_bf16_f32 v138, v84, v85
  v_cvt_pk_bf16_f32 v139, v86, v87
  v_cvt_pk_bf16_f32 v140, v88, v89
  v_cvt_pk_bf16_f32 v141, v90, v91
  v_cvt_pk_bf16_f32 v142, v92, v93
  v_cvt_pk_bf16_f32 v143, v94, v95
  s_waitcnt lgkmcnt(0)
  ds_read_b64_tr_b16 v[208:209], v60
  ds_read_b64_tr_b16 v[210:211], v60 offset:1024
  v_xor_b32 v1, 32, v60
  ds_read_b64_tr_b16 v[212:213], v1
  ds_read_b64_tr_b16 v[214:215], v1 offset:1024
  v_xor_b32 v1, 64, v60
  ds_read_b64_tr_b16 v[216:217], v1
  ds_read_b64_tr_b16 v[218:219], v1 offset:1024
  v_xor_b32 v1, 96, v60
  ds_read_b64_tr_b16 v[220:221], v1
  ds_read_b64_tr_b16 v[222:223], v1 offset:1024
  v_cvt_pk_bf16_f32 v144, v96, v97
  v_cvt_pk_bf16_f32 v145, v98, v99
  v_cvt_pk_bf16_f32 v146, v100, v101
  v_cvt_pk_bf16_f32 v147, v102, v103
  v_cvt_pk_bf16_f32 v148, v104, v105
  v_cvt_pk_bf16_f32 v149, v106, v107
  v_cvt_pk_bf16_f32 v150, v108, v109
  v_cvt_pk_bf16_f32 v151, v110, v111
  v_cvt_pk_bf16_f32 v152, v112, v113
  v_cvt_pk_bf16_f32 v153, v114, v115
  v_cvt_pk_bf16_f32 v154, v116, v117
  v_cvt_pk_bf16_f32 v155, v118, v119
  v_cvt_pk_bf16_f32 v156, v120, v121
  v_cvt_pk_bf16_f32 v157, v122, v123
  v_cvt_pk_bf16_f32 v158, v124, v125
  v_cvt_pk_bf16_f32 v159, v126, v127
  s_nop 1
  v_permlane16_swap_b32 v128, v132
  v_permlane16_swap_b32 v129, v133
  v_permlane16_swap_b32 v130, v134
  v_permlane16_swap_b32 v131, v135
  v_permlane16_swap_b32 v136, v140
  v_permlane16_swap_b32 v137, v141
  v_permlane16_swap_b32 v138, v142
  v_permlane16_swap_b32 v139, v143
  v_permlane16_swap_b32 v144, v148
  v_permlane16_swap_b32 v145, v149
  v_permlane16_swap_b32 v146, v150
  v_permlane16_swap_b32 v147, v151
  v_permlane16_swap_b32 v152, v156
  v_permlane16_swap_b32 v153, v157
  v_permlane16_swap_b32 v154, v158
  v_permlane16_swap_b32 v155, v159
  s_waitcnt lgkmcnt(4)
  v_xor_b32 v1, 128, v60
  ds_read_b64_tr_b16 v[224:225], v1
  ds_read_b64_tr_b16 v[226:227], v1 offset:1024
  v_xor_b32 v1, 160, v60
  ds_read_b64_tr_b16 v[228:229], v1
  ds_read_b64_tr_b16 v[230:231], v1 offset:1024
  v_xor_b32 v1, 192, v60
  ds_read_b64_tr_b16 v[232:233], v1
  ds_read_b64_tr_b16 v[234:235], v1 offset:1024
  v_xor_b32 v1, 224, v60
  ds_read_b64_tr_b16 v[236:237], v1
  ds_read_b64_tr_b16 v[238:239], v1 offset:1024
  v_mfma_f32_16x16x32_bf16 v[192:195], v[160:163], v[128:131], 0
  v_mfma_f32_16x16x32_bf16 v[196:199], v[160:163], v[132:135], 0
  v_mfma_f32_16x16x32_bf16 v[200:203], v[176:179], v[128:131], 0
  v_mfma_f32_16x16x32_bf16 v[204:207], v[176:179], v[132:135], 0
  v_mfma_f32_16x16x32_bf16 v[192:195], v[164:167], v[136:139], v[192:195]
  v_mfma_f32_16x16x32_bf16 v[196:199], v[164:167], v[140:143], v[196:199]
  v_mfma_f32_16x16x32_bf16 v[200:203], v[180:183], v[136:139], v[200:203]
  v_mfma_f32_16x16x32_bf16 v[204:207], v[180:183], v[140:143], v[204:207]
  v_mfma_f32_16x16x32_bf16 v[192:195], v[168:171], v[144:147], v[192:195]
  v_mfma_f32_16x16x32_bf16 v[196:199], v[168:171], v[148:151], v[196:199]
  v_mfma_f32_16x16x32_bf16 v[200:203], v[184:187], v[144:147], v[200:203]
  v_mfma_f32_16x16x32_bf16 v[204:207], v[184:187], v[148:151], v[204:207]
  v_mfma_f32_16x16x32_bf16 v[192:195], v[172:175], v[152:155], v[192:195]
  v_mfma_f32_16x16x32_bf16 v[196:199], v[172:175], v[156:159], v[196:199]
  v_mfma_f32_16x16x32_bf16 v[200:203], v[188:191], v[152:155], v[200:203]
  v_mfma_f32_16x16x32_bf16 v[204:207], v[188:191], v[156:159], v[204:207]
  s_waitcnt lgkmcnt(0)
  s_nop 7
  v_max3_f32 v48, v192, v193, v194
  v_max3_f32 v49, v196, v197, v198
  v_max3_f32 v48, v48, v195, v200
  v_max3_f32 v49, v49, v199, v204
  v_max3_f32 v48, v48, v201, v202
  v_max3_f32 v49, v49, v205, v206
  v_max_f32 v48, v48, v203
  v_max_f32 v49, v49, v207
  v_mov_b32 v50, v48
  v_mov_b32 v51, v49
  s_nop 0
  v_permlane16_swap_b32 v50, v48
  v_permlane16_swap_b32 v51, v49
  s_nop 0
  v_max_f32 v48, v48, v50
  v_max_f32 v49, v49, v51
  v_mov_b32 v50, v48
  v_mov_b32 v51, v49
  s_nop 0
  v_permlane32_swap_b32 v50, v48
  v_permlane32_swap_b32 v51, v49
  s_nop 0
  v_max_f32 v48, v48, v50
  v_max_f32 v49, v49, v51
  s_mov_b32 s41, 0x3e0293ee
  v_mul_f32 v48, s41, v48
  v_mul_f32 v49, s41, v49
  v_fma_f32 v192, v192, s41, -v48
  v_fma_f32 v196, v196, s41, -v49
  v_fma_f32 v193, v193, s41, -v48
  v_fma_f32 v197, v197, s41, -v49
  v_fma_f32 v194, v194, s41, -v48
  v_fma_f32 v198, v198, s41, -v49
  v_fma_f32 v195, v195, s41, -v48
  v_fma_f32 v199, v199, s41, -v49
  v_fma_f32 v200, v200, s41, -v48
  v_fma_f32 v204, v204, s41, -v49
  v_fma_f32 v201, v201, s41, -v48
  v_fma_f32 v205, v205, s41, -v49
  v_fma_f32 v202, v202, s41, -v48
  v_fma_f32 v206, v206, s41, -v49
  v_fma_f32 v203, v203, s41, -v48
  v_fma_f32 v207, v207, s41, -v49
  v_exp_f32 v192, v192
  v_exp_f32 v196, v196
  v_exp_f32 v193, v193
  v_exp_f32 v197, v197
  v_exp_f32 v194, v194
  v_exp_f32 v198, v198
  v_exp_f32 v195, v195
  v_exp_f32 v199, v199
  v_exp_f32 v200, v200
  v_exp_f32 v204, v204
  v_exp_f32 v201, v201
  v_exp_f32 v205, v205
  v_exp_f32 v202, v202
  v_exp_f32 v206, v206
  v_exp_f32 v203, v203
  v_exp_f32 v207, v207
  s_nop 0
  v_add_f32 v52, v192, v193
  v_add_f32 v53, v196, v197
  v_add_f32 v52, v52, v194
  v_add_f32 v53, v53, v198
  v_add_f32 v52, v52, v195
  v_add_f32 v53, v53, v199
  v_add_f32 v52, v52, v200
  v_add_f32 v53, v53, v204
  v_add_f32 v52, v52, v201
  v_add_f32 v53, v53, v205
  v_add_f32 v52, v52, v202
  v_add_f32 v53, v53, v206
  v_add_f32 v52, v52, v203
  v_add_f32 v53, v53, v207
  v_mov_b32 v50, v52
  v_mov_b32 v51, v53
  s_nop 0
  v_permlane16_swap_b32 v50, v52
  v_permlane16_swap_b32 v51, v53
  s_nop 0
  v_add_f32 v52, v52, v50
  v_add_f32 v53, v53, v51
  v_mov_b32 v50, v52
  v_mov_b32 v51, v53
  s_nop 0
  v_permlane32_swap_b32 v50, v52
  v_permlane32_swap_b32 v51, v53
  s_nop 0
  v_add_f32 v52, v52, v50
  v_add_f32 v53, v53, v51
  v_rcp_f32 v52, v52
  v_rcp_f32 v53, v53
  s_nop 0
  v_mul_f32 v192, v192, v52
  v_mul_f32 v196, v196, v53
  v_mul_f32 v193, v193, v52
  v_mul_f32 v197, v197, v53
  v_mul_f32 v194, v194, v52
  v_mul_f32 v198, v198, v53
  v_mul_f32 v195, v195, v52
  v_mul_f32 v199, v199, v53
  v_mul_f32 v200, v200, v52
  v_mul_f32 v204, v204, v53
  v_mul_f32 v201, v201, v52
  v_mul_f32 v205, v205, v53
  v_mul_f32 v202, v202, v52
  v_mul_f32 v206, v206, v53
  v_mul_f32 v203, v203, v52
  v_mul_f32 v207, v207, v53
  v_cvt_pk_bf16_f32 v240, v192, v193
  v_cvt_pk_bf16_f32 v241, v194, v195
  v_cvt_pk_bf16_f32 v242, v200, v201
  v_cvt_pk_bf16_f32 v243, v202, v203
  v_cvt_pk_bf16_f32 v244, v196, v197
  v_cvt_pk_bf16_f32 v245, v198, v199
  v_cvt_pk_bf16_f32 v246, v204, v205
  v_cvt_pk_bf16_f32 v247, v206, v207
  s_nop 0
  s_mov_b32 s32, s30
  s_and_b32 s33, s31, 0xffff
  s_mov_b32 s34, 67108864
  s_mov_b32 s35, 0x00020000
  v_lshlrev_b32 v7, 4, v0
  s_lshl_b32 s40, s9, 5
  s_add_u32 s40, s40, s10
  s_lshl_b32 s40, s40, 2
  s_add_u32 s40, s40, s3
  s_lshl_b32 s40, s40, 13
  s_add_u32 s41, s40, 4096
  v_lshrrev_b32 v2, 4, v0
  v_bfe_u32 v3, v0, 2, 2
  v_lshl_add_u32 v2, v2, 2, v3
  v_mul_u32_u24 v2, 288, v2
  v_and_b32 v3, 3, v0
  v_lshl_add_u32 v4, v3, 3, v2
  v_add_u32 v5, 36864, v4
  v_add_u32 v6, 73728, v4
  v_add_u32 v12, 110592, v4
  s_lshl_b32 s44, s9, 5
  s_lshl_b32 s45, s4, 2
  s_add_u32 s44, s44, s45
  s_lshl_b32 s48, s9, 3
  s_add_u32 s48, s48, s4
  s_lshl_b32 s48, s48, 2
  s_add_u32 s48, s48, s3
  s_lshl_b32 s48, s48, 7
  s_add_u32 s48, s48, 29360128
  s_lshl_b32 s49, s6, 3
  s_add_u32 s49, s49, s48
  v_and_b32 v8, 3, v0
  v_lshlrev_b32 v8, 3, v8
  s_nop 0
  v_mfma_f32_16x16x32_bf16 v[64:67], v[208:211], v[240:243], 0
  v_mfma_f32_16x16x32_bf16 v[68:71], v[208:211], v[244:247], 0
  v_mfma_f32_16x16x32_bf16 v[72:75], v[212:215], v[240:243], 0
  v_mfma_f32_16x16x32_bf16 v[76:79], v[212:215], v[244:247], 0
  v_mfma_f32_16x16x32_bf16 v[80:83], v[216:219], v[240:243], 0
  v_mfma_f32_16x16x32_bf16 v[84:87], v[216:219], v[244:247], 0
  v_mfma_f32_16x16x32_bf16 v[88:91], v[220:223], v[240:243], 0
  v_mfma_f32_16x16x32_bf16 v[92:95], v[220:223], v[244:247], 0
  v_mfma_f32_16x16x32_bf16 v[96:99], v[224:227], v[240:243], 0
  v_mfma_f32_16x16x32_bf16 v[100:103], v[224:227], v[244:247], 0
  v_mfma_f32_16x16x32_bf16 v[104:107], v[228:231], v[240:243], 0
  v_mfma_f32_16x16x32_bf16 v[108:111], v[228:231], v[244:247], 0
  v_cvt_pk_bf16_f32 v128, v64, v65
  v_cvt_pk_bf16_f32 v129, v66, v67
  v_cvt_pk_bf16_f32 v130, v72, v73
  v_cvt_pk_bf16_f32 v131, v74, v75
  v_cvt_pk_bf16_f32 v132, v68, v69
  v_cvt_pk_bf16_f32 v133, v70, v71
  v_cvt_pk_bf16_f32 v134, v76, v77
  v_cvt_pk_bf16_f32 v135, v78, v79
  v_mfma_f32_16x16x32_bf16 v[112:115], v[232:235], v[240:243], 0
  v_mfma_f32_16x16x32_bf16 v[116:119], v[232:235], v[244:247], 0
  buffer_store_dwordx4 v[128:131], v7, s[32:35], s40 offen offset:0 sc1
  buffer_store_dwordx4 v[132:135], v7, s[32:35], s40 offen offset:1024 sc1
  v_mfma_f32_16x16x32_bf16 v[120:123], v[236:239], v[240:243], 0
  v_mfma_f32_16x16x32_bf16 v[124:127], v[236:239], v[244:247], 0
  v_cvt_pk_bf16_f32 v136, v80, v81
  v_cvt_pk_bf16_f32 v137, v82, v83
  v_cvt_pk_bf16_f32 v138, v88, v89
  v_cvt_pk_bf16_f32 v139, v90, v91
  v_cvt_pk_bf16_f32 v140, v84, v85
  v_cvt_pk_bf16_f32 v141, v86, v87
  v_cvt_pk_bf16_f32 v142, v92, v93
  v_cvt_pk_bf16_f32 v143, v94, v95
  buffer_store_dwordx4 v[136:139], v7, s[32:35], s40 offen offset:2048 sc1
  buffer_store_dwordx4 v[140:143], v7, s[32:35], s40 offen offset:3072 sc1
  s_nop 0
  v_cvt_pk_bf16_f32 v144, v96, v97
  v_cvt_pk_bf16_f32 v145, v98, v99
  v_cvt_pk_bf16_f32 v146, v104, v105
  v_cvt_pk_bf16_f32 v147, v106, v107
  v_cvt_pk_bf16_f32 v148, v100, v101
  v_cvt_pk_bf16_f32 v149, v102, v103
  v_cvt_pk_bf16_f32 v150, v108, v109
  v_cvt_pk_bf16_f32 v151, v110, v111
  buffer_store_dwordx4 v[144:147], v7, s[32:35], s41 offen offset:0 sc1
  buffer_store_dwordx4 v[148:151], v7, s[32:35], s41 offen offset:1024 sc1
  s_nop 1
  v_cvt_pk_bf16_f32 v152, v112, v113
  v_cvt_pk_bf16_f32 v153, v114, v115
  v_cvt_pk_bf16_f32 v154, v120, v121
  v_cvt_pk_bf16_f32 v155, v122, v123
  v_cvt_pk_bf16_f32 v156, v116, v117
  v_cvt_pk_bf16_f32 v157, v118, v119
  v_cvt_pk_bf16_f32 v158, v124, v125
  v_cvt_pk_bf16_f32 v159, v126, v127
  buffer_store_dwordx4 v[152:155], v7, s[32:35], s41 offen offset:2048 sc1
  buffer_store_dwordx4 v[156:159], v7, s[32:35], s41 offen offset:3072 sc1
  s_barrier
  ds_read_b64_tr_b16 v[88:89], v4 offset:0
  ds_read_b64_tr_b16 v[90:91], v4 offset:4608
  ds_read_b64_tr_b16 v[92:93], v4 offset:32
  ds_read_b64_tr_b16 v[94:95], v4 offset:4640
  ds_read_b64_tr_b16 v[96:97], v4 offset:64
  ds_read_b64_tr_b16 v[98:99], v4 offset:4672
  ds_read_b64_tr_b16 v[100:101], v4 offset:96
  ds_read_b64_tr_b16 v[102:103], v4 offset:4704
  ds_read_b64_tr_b16 v[104:105], v4 offset:128
  ds_read_b64_tr_b16 v[106:107], v4 offset:4736
  s_waitcnt lgkmcnt(8)
  v_mfma_f32_16x16x32_bf16 v[16:19], v[88:91], v[128:131], 0
  ds_read_b64_tr_b16 v[108:109], v4 offset:160
  v_mfma_f32_16x16x32_bf16 v[20:23], v[88:91], v[132:135], 0
  ds_read_b64_tr_b16 v[110:111], v4 offset:4768
  s_waitcnt lgkmcnt(8)
  v_mfma_f32_16x16x32_bf16 v[24:27], v[92:95], v[128:131], 0
  ds_read_b64_tr_b16 v[112:113], v4 offset:192
  v_mfma_f32_16x16x32_bf16 v[28:31], v[92:95], v[132:135], 0
  ds_read_b64_tr_b16 v[114:115], v4 offset:4800
  s_waitcnt lgkmcnt(8)
  v_mfma_f32_16x16x32_bf16 v[32:35], v[96:99], v[128:131], 0
  ds_read_b64_tr_b16 v[116:117], v4 offset:224
  v_mfma_f32_16x16x32_bf16 v[36:39], v[96:99], v[132:135], 0
  ds_read_b64_tr_b16 v[118:119], v4 offset:4832
  s_waitcnt lgkmcnt(8)
  v_mfma_f32_16x16x32_bf16 v[40:43], v[100:103], v[128:131], 0
  ds_read_b64_tr_b16 v[120:121], v4 offset:256
  v_mfma_f32_16x16x32_bf16 v[44:47], v[100:103], v[132:135], 0
  ds_read_b64_tr_b16 v[122:123], v4 offset:4864
  s_waitcnt lgkmcnt(8)
  v_mfma_f32_16x16x32_bf16 v[48:51], v[104:107], v[128:131], 0
  v_mfma_f32_16x16x32_bf16 v[52:55], v[104:107], v[132:135], 0
  s_waitcnt lgkmcnt(6)
  v_mfma_f32_16x16x32_bf16 v[56:59], v[108:111], v[128:131], 0
  ds_read_b64_tr_b16 v[88:89], v4 offset:9216
  ds_read_b64_tr_b16 v[90:91], v4 offset:13824
  v_mfma_f32_16x16x32_bf16 v[60:63], v[108:111], v[132:135], 0
  ds_read_b64_tr_b16 v[92:93], v4 offset:9248
  ds_read_b64_tr_b16 v[94:95], v4 offset:13856
  s_waitcnt lgkmcnt(8)
  v_mfma_f32_16x16x32_bf16 v[64:67], v[112:115], v[128:131], 0
  ds_read_b64_tr_b16 v[96:97], v4 offset:9280
  v_mfma_f32_16x16x32_bf16 v[68:71], v[112:115], v[132:135], 0
  ds_read_b64_tr_b16 v[98:99], v4 offset:13888
  s_waitcnt lgkmcnt(8)
  v_mfma_f32_16x16x32_bf16 v[72:75], v[116:119], v[128:131], 0
  ds_read_b64_tr_b16 v[100:101], v4 offset:9312
  v_mfma_f32_16x16x32_bf16 v[76:79], v[116:119], v[132:135], 0
  ds_read_b64_tr_b16 v[102:103], v4 offset:13920
  s_waitcnt lgkmcnt(8)
  v_mfma_f32_16x16x32_bf16 v[80:83], v[120:123], v[128:131], 0
  ds_read_b64_tr_b16 v[104:105], v4 offset:9344
  v_mfma_f32_16x16x32_bf16 v[84:87], v[120:123], v[132:135], 0
  ds_read_b64_tr_b16 v[106:107], v4 offset:13952
  s_waitcnt lgkmcnt(8)
  v_mfma_f32_16x16x32_bf16 v[16:19], v[88:91], v[136:139], v[16:19]
  ds_read_b64_tr_b16 v[108:109], v4 offset:9376
  v_mfma_f32_16x16x32_bf16 v[20:23], v[88:91], v[140:143], v[20:23]
  ds_read_b64_tr_b16 v[110:111], v4 offset:13984
  s_waitcnt lgkmcnt(8)
  v_mfma_f32_16x16x32_bf16 v[24:27], v[92:95], v[136:139], v[24:27]
  ds_read_b64_tr_b16 v[112:113], v4 offset:9408
  v_mfma_f32_16x16x32_bf16 v[28:31], v[92:95], v[140:143], v[28:31]
  ds_read_b64_tr_b16 v[114:115], v4 offset:14016
  s_waitcnt lgkmcnt(8)
  v_mfma_f32_16x16x32_bf16 v[32:35], v[96:99], v[136:139], v[32:35]
  ds_read_b64_tr_b16 v[116:117], v4 offset:9440
  v_mfma_f32_16x16x32_bf16 v[36:39], v[96:99], v[140:143], v[36:39]
  ds_read_b64_tr_b16 v[118:119], v4 offset:14048
  s_waitcnt lgkmcnt(8)
  v_mfma_f32_16x16x32_bf16 v[40:43], v[100:103], v[136:139], v[40:43]
  ds_read_b64_tr_b16 v[120:121], v4 offset:9472
  v_mfma_f32_16x16x32_bf16 v[44:47], v[100:103], v[140:143], v[44:47]
  ds_read_b64_tr_b16 v[122:123], v4 offset:14080
  s_waitcnt lgkmcnt(8)
  v_mfma_f32_16x16x32_bf16 v[48:51], v[104:107], v[136:139], v[48:51]
  v_mfma_f32_16x16x32_bf16 v[52:55], v[104:107], v[140:143], v[52:55]
  s_waitcnt vmcnt(0)
  v_mov_b32 v10, s52
  v_mov_b32 v11, s53
  s_mov_b64 exec, 1
  s_cmp_eq_u32 s54, 0
  s_cbranch_scc1 L_flag_slow
  buffer_store_dwordx2 v[10:11], v9, s[32:35], s49 offen
  s_branch L_flag_join
L_flag_slow:
  buffer_store_dwordx2 v[10:11], v9, s[32:35], s49 offen sc1
L_flag_join:
  s_mov_b64 exec, -1
  s_add_u32 s56, s6, 1
  s_and_b32 s56, s56, 3
  s_mov_b32 s50, 0
L_poll_o1:
  buffer_load_dwordx2 v[10:11], v8, s[32:35], s48 offen sc1
  s_add_u32 s50, s50, 1
  s_waitcnt vmcnt(0)
  v_cmp_eq_u64 vcc, v[10:11], s[52:53]
  s_cmp_ge_u32 s50, 200000
  s_cbranch_scc1 L_poll_o1_done
  s_bitcmp1_b32 vcc_lo, s56
  s_cbranch_scc0 L_poll_o1
L_poll_o1_done:
  s_cmp_eq_u64 vcc, -1
  s_cselect_b32 s55, 1, 0
  s_add_u32 s45, s6, 1
  s_and_b32 s45, s45, 3
  s_add_u32 s45, s45, s44
  s_lshl_b32 s45, s45, 2
  s_add_u32 s45, s45, s3
  s_lshl_b32 s46, s45, 13
  s_add_u32 s47, s46, 4096
  buffer_load_dwordx4 v[160:163], v7, s[32:35], s46 offen offset:0 sc1
  buffer_load_dwordx4 v[164:167], v7, s[32:35], s46 offen offset:1024 sc1
  buffer_load_dwordx4 v[168:171], v7, s[32:35], s46 offen offset:2048 sc1
  buffer_load_dwordx4 v[172:175], v7, s[32:35], s46 offen offset:3072 sc1
  buffer_load_dwordx4 v[176:179], v7, s[32:35], s47 offen offset:0 sc1
  buffer_load_dwordx4 v[180:183], v7, s[32:35], s47 offen offset:1024 sc1
  buffer_load_dwordx4 v[184:187], v7, s[32:35], s47 offen offset:2048 sc1
  buffer_load_dwordx4 v[188:191], v7, s[32:35], s47 offen offset:3072 sc1
  s_nop 3
  s_waitcnt lgkmcnt(6)
  v_mfma_f32_16x16x32_bf16 v[56:59], v[108:111], v[136:139], v[56:59]
  ds_read_b64_tr_b16 v[88:89], v4 offset:18432
  ds_read_b64_tr_b16 v[90:91], v4 offset:23040
  v_mfma_f32_16x16x32_bf16 v[60:63], v[108:111], v[140:143], v[60:63]
  ds_read_b64_tr_b16 v[92:93], v4 offset:18464
  ds_read_b64_tr_b16 v[94:95], v4 offset:23072
  s_waitcnt lgkmcnt(8)
  v_mfma_f32_16x16x32_bf16 v[64:67], v[112:115], v[136:139], v[64:67]
  ds_read_b64_tr_b16 v[96:97], v4 offset:18496
  v_mfma_f32_16x16x32_bf16 v[68:71], v[112:115], v[140:143], v[68:71]
  ds_read_b64_tr_b16 v[98:99], v4 offset:23104
  s_waitcnt lgkmcnt(8)
  v_mfma_f32_16x16x32_bf16 v[72:75], v[116:119], v[136:139], v[72:75]
  ds_read_b64_tr_b16 v[100:101], v4 offset:18528
  v_mfma_f32_16x16x32_bf16 v[76:79], v[116:119], v[140:143], v[76:79]
  ds_read_b64_tr_b16 v[102:103], v4 offset:23136
  s_waitcnt lgkmcnt(8)
  v_mfma_f32_16x16x32_bf16 v[80:83], v[120:123], v[136:139], v[80:83]
  ds_read_b64_tr_b16 v[104:105], v4 offset:18560
  v_mfma_f32_16x16x32_bf16 v[84:87], v[120:123], v[140:143], v[84:87]
  ds_read_b64_tr_b16 v[106:107], v4 offset:23168
  s_waitcnt lgkmcnt(8)
  v_mfma_f32_16x16x32_bf16 v[16:19], v[88:91], v[144:147], v[16:19]
  ds_read_b64_tr_b16 v[108:109], v4 offset:18592
  v_mfma_f32_16x16x32_bf16 v[20:23], v[88:91], v[148:151], v[20:23]
  ds_read_b64_tr_b16 v[110:111], v4 offset:23200
  s_waitcnt lgkmcnt(8)
  v_mfma_f32_16x16x32_bf16 v[24:27], v[92:95], v[144:147], v[24:27]
  ds_read_b64_tr_b16 v[112:113], v4 offset:18624
  v_mfma_f32_16x16x32_bf16 v[28:31], v[92:95], v[148:151], v[28:31]
  ds_read_b64_tr_b16 v[114:115], v4 offset:23232
  s_waitcnt lgkmcnt(8)
  v_mfma_f32_16x16x32_bf16 v[32:35], v[96:99], v[144:147], v[32:35]
  ds_read_b64_tr_b16 v[116:117], v4 offset:18656
  v_mfma_f32_16x16x32_bf16 v[36:39], v[96:99], v[148:151], v[36:39]
  ds_read_b64_tr_b16 v[118:119], v4 offset:23264
  s_waitcnt lgkmcnt(8)
  v_mfma_f32_16x16x32_bf16 v[40:43], v[100:103], v[144:147], v[40:43]
  ds_read_b64_tr_b16 v[120:121], v4 offset:18688
  v_mfma_f32_16x16x32_bf16 v[44:47], v[100:103], v[148:151], v[44:47]
  ds_read_b64_tr_b16 v[122:123], v4 offset:23296
  s_waitcnt lgkmcnt(8)
  v_mfma_f32_16x16x32_bf16 v[48:51], v[104:107], v[144:147], v[48:51]
  v_mfma_f32_16x16x32_bf16 v[52:55], v[104:107], v[148:151], v[52:55]
  s_waitcnt lgkmcnt(6)
  v_mfma_f32_16x16x32_bf16 v[56:59], v[108:111], v[144:147], v[56:59]
  ds_read_b64_tr_b16 v[88:89], v4 offset:27648
  ds_read_b64_tr_b16 v[90:91], v4 offset:32256
  v_mfma_f32_16x16x32_bf16 v[60:63], v[108:111], v[148:151], v[60:63]
  ds_read_b64_tr_b16 v[92:93], v4 offset:27680
  ds_read_b64_tr_b16 v[94:95], v4 offset:32288
  s_waitcnt lgkmcnt(8)
  v_mfma_f32_16x16x32_bf16 v[64:67], v[112:115], v[144:147], v[64:67]
  ds_read_b64_tr_b16 v[96:97], v4 offset:27712
  v_mfma_f32_16x16x32_bf16 v[68:71], v[112:115], v[148:151], v[68:71]
  ds_read_b64_tr_b16 v[98:99], v4 offset:32320
  s_waitcnt lgkmcnt(8)
  v_mfma_f32_16x16x32_bf16 v[72:75], v[116:119], v[144:147], v[72:75]
  ds_read_b64_tr_b16 v[100:101], v4 offset:27744
  v_mfma_f32_16x16x32_bf16 v[76:79], v[116:119], v[148:151], v[76:79]
  ds_read_b64_tr_b16 v[102:103], v4 offset:32352
  s_waitcnt lgkmcnt(8)
  v_mfma_f32_16x16x32_bf16 v[80:83], v[120:123], v[144:147], v[80:83]
  ds_read_b64_tr_b16 v[104:105], v4 offset:27776
  v_mfma_f32_16x16x32_bf16 v[84:87], v[120:123], v[148:151], v[84:87]
  ds_read_b64_tr_b16 v[106:107], v4 offset:32384
  s_waitcnt lgkmcnt(8)
  v_mfma_f32_16x16x32_bf16 v[16:19], v[88:91], v[152:155], v[16:19]
  ds_read_b64_tr_b16 v[108:109], v4 offset:27808
  v_mfma_f32_16x16x32_bf16 v[20:23], v[88:91], v[156:159], v[20:23]
  ds_read_b64_tr_b16 v[110:111], v4 offset:32416
  s_waitcnt lgkmcnt(8)
  v_mfma_f32_16x16x32_bf16 v[24:27], v[92:95], v[152:155], v[24:27]
  ds_read_b64_tr_b16 v[112:113], v4 offset:27840
  v_mfma_f32_16x16x32_bf16 v[28:31], v[92:95], v[156:159], v[28:31]
  ds_read_b64_tr_b16 v[114:115], v4 offset:32448
  s_waitcnt lgkmcnt(8)
  v_mfma_f32_16x16x32_bf16 v[32:35], v[96:99], v[152:155], v[32:35]
  ds_read_b64_tr_b16 v[116:117], v4 offset:27872
  v_mfma_f32_16x16x32_bf16 v[36:39], v[96:99], v[156:159], v[36:39]
  ds_read_b64_tr_b16 v[118:119], v4 offset:32480
  s_waitcnt lgkmcnt(8)
  v_mfma_f32_16x16x32_bf16 v[40:43], v[100:103], v[152:155], v[40:43]
  ds_read_b64_tr_b16 v[120:121], v4 offset:27904
  v_mfma_f32_16x16x32_bf16 v[44:47], v[100:103], v[156:159], v[44:47]
  ds_read_b64_tr_b16 v[122:123], v4 offset:32512
  s_waitcnt lgkmcnt(8)
  v_mfma_f32_16x16x32_bf16 v[48:51], v[104:107], v[152:155], v[48:51]
  v_mfma_f32_16x16x32_bf16 v[52:55], v[104:107], v[156:159], v[52:55]
  s_waitcnt lgkmcnt(6)
  v_mfma_f32_16x16x32_bf16 v[56:59], v[108:111], v[152:155], v[56:59]
  v_mfma_f32_16x16x32_bf16 v[60:63], v[108:111], v[156:159], v[60:63]
  s_waitcnt lgkmcnt(4)
  v_mfma_f32_16x16x32_bf16 v[64:67], v[112:115], v[152:155], v[64:67]
  v_mfma_f32_16x16x32_bf16 v[68:71], v[112:115], v[156:159], v[68:71]
  s_waitcnt lgkmcnt(2)
  v_mfma_f32_16x16x32_bf16 v[72:75], v[116:119], v[152:155], v[72:75]
  v_mfma_f32_16x16x32_bf16 v[76:79], v[116:119], v[156:159], v[76:79]
  s_waitcnt lgkmcnt(0)
  v_mfma_f32_16x16x32_bf16 v[80:83], v[120:123], v[152:155], v[80:83]
  v_mfma_f32_16x16x32_bf16 v[84:87], v[120:123], v[156:159], v[84:87]
  s_barrier
  s_cmp_eq_u32 s55, 1
  s_cbranch_scc1 L_poll_o_skip
  s_mov_b32 s50, 0
L_poll_o:
  buffer_load_dwordx2 v[10:11], v8, s[32:35], s48 offen sc1
  s_add_u32 s50, s50, 1
  s_waitcnt vmcnt(0)
  v_cmp_eq_u64 vcc, v[10:11], s[52:53]
  s_cmp_ge_u32 s50, 200000
  s_cbranch_scc1 L_poll_o_done
  s_cmp_eq_u64 vcc, -1
  s_cbranch_scc0 L_poll_o
L_poll_o_done:
L_poll_o_skip:
  ds_read_b64_tr_b16 v[88:89], v5 offset:0
  ds_read_b64_tr_b16 v[90:91], v5 offset:4608
  ds_read_b64_tr_b16 v[92:93], v5 offset:32
  ds_read_b64_tr_b16 v[94:95], v5 offset:4640
  ds_read_b64_tr_b16 v[96:97], v5 offset:64
  ds_read_b64_tr_b16 v[98:99], v5 offset:4672
  ds_read_b64_tr_b16 v[100:101], v5 offset:96
  ds_read_b64_tr_b16 v[102:103], v5 offset:4704
  ds_read_b64_tr_b16 v[104:105], v5 offset:128
  ds_read_b64_tr_b16 v[106:107], v5 offset:4736
  s_add_u32 s45, s6, 2
  s_and_b32 s45, s45, 3
  s_add_u32 s45, s45, s44
  s_lshl_b32 s45, s45, 2
  s_add_u32 s45, s45, s3
  s_lshl_b32 s46, s45, 13
  s_add_u32 s47, s46, 4096
  v_bfe_u32 v13, v0, 1, 3
  v_mul_u32_u24 v13, 9216, v13
  v_lshrrev_b32 v14, 4, v0
  v_lshlrev_b32 v14, 1, v14
  v_and_b32 v15, 1, v0
  v_add_u32 v14, v14, v15
  v_lshl_add_u32 v13, v14, 4, v13
  s_lshl_b32 s58, s9, 2
  s_add_u32 s58, s58, s6
  s_lshl_b32 s58, s58, 2
  s_add_u32 s58, s58, s3
  s_mul_i32 s59, s58, 73728
  s_add_u32 s59, s59, 8388608
  s_mul_i32 s40, s4, 1152
  s_add_u32 s40, s40, s59
  s_waitcnt vmcnt(6)
  s_waitcnt lgkmcnt(8)
  v_mfma_f32_16x16x32_bf16 v[16:19], v[88:91], v[160:163], v[16:19]
  ds_read_b64_tr_b16 v[108:109], v5 offset:160
  v_mfma_f32_16x16x32_bf16 v[20:23], v[88:91], v[164:167], v[20:23]
  ds_read_b64_tr_b16 v[110:111], v5 offset:4768
  s_waitcnt lgkmcnt(8)
  v_mfma_f32_16x16x32_bf16 v[24:27], v[92:95], v[160:163], v[24:27]
  ds_read_b64_tr_b16 v[112:113], v5 offset:192
  v_mfma_f32_16x16x32_bf16 v[28:31], v[92:95], v[164:167], v[28:31]
  ds_read_b64_tr_b16 v[114:115], v5 offset:4800
  s_waitcnt lgkmcnt(8)
  v_mfma_f32_16x16x32_bf16 v[32:35], v[96:99], v[160:163], v[32:35]
  ds_read_b64_tr_b16 v[116:117], v5 offset:224
  v_mfma_f32_16x16x32_bf16 v[36:39], v[96:99], v[164:167], v[36:39]
  ds_read_b64_tr_b16 v[118:119], v5 offset:4832
  s_waitcnt lgkmcnt(8)
  v_mfma_f32_16x16x32_bf16 v[40:43], v[100:103], v[160:163], v[40:43]
  ds_read_b64_tr_b16 v[120:121], v5 offset:256
  v_mfma_f32_16x16x32_bf16 v[44:47], v[100:103], v[164:167], v[44:47]
  ds_read_b64_tr_b16 v[122:123], v5 offset:4864
  s_waitcnt lgkmcnt(8)
  v_mfma_f32_16x16x32_bf16 v[48:51], v[104:107], v[160:163], v[48:51]
  buffer_load_dwordx4 v[192:195], v7, s[32:35], s46 offen offset:0 sc1
  v_mfma_f32_16x16x32_bf16 v[52:55], v[104:107], v[164:167], v[52:55]
  buffer_load_dwordx4 v[196:199], v7, s[32:35], s46 offen offset:1024 sc1
  s_waitcnt lgkmcnt(6)
  v_mfma_f32_16x16x32_bf16 v[56:59], v[108:111], v[160:163], v[56:59]
  ds_read_b64_tr_b16 v[88:89], v5 offset:9216
  ds_read_b64_tr_b16 v[90:91], v5 offset:13824
  v_mfma_f32_16x16x32_bf16 v[60:63], v[108:111], v[164:167], v[60:63]
  ds_read_b64_tr_b16 v[92:93], v5 offset:9248
  ds_read_b64_tr_b16 v[94:95], v5 offset:13856
  s_waitcnt lgkmcnt(8)
  v_mfma_f32_16x16x32_bf16 v[64:67], v[112:115], v[160:163], v[64:67]
  ds_read_b64_tr_b16 v[96:97], v5 offset:9280
  v_mfma_f32_16x16x32_bf16 v[68:71], v[112:115], v[164:167], v[68:71]
  ds_read_b64_tr_b16 v[98:99], v5 offset:13888
  s_waitcnt lgkmcnt(8)
  v_mfma_f32_16x16x32_bf16 v[72:75], v[116:119], v[160:163], v[72:75]
  ds_read_b64_tr_b16 v[100:101], v5 offset:9312
  v_mfma_f32_16x16x32_bf16 v[76:79], v[116:119], v[164:167], v[76:79]
  ds_read_b64_tr_b16 v[102:103], v5 offset:13920
  s_waitcnt lgkmcnt(8)
  v_mfma_f32_16x16x32_bf16 v[80:83], v[120:123], v[160:163], v[80:83]
  ds_read_b64_tr_b16 v[104:105], v5 offset:9344
  buffer_load_dwordx4 v[200:203], v7, s[32:35], s46 offen offset:2048 sc1
  v_mfma_f32_16x16x32_bf16 v[84:87], v[120:123], v[164:167], v[84:87]
  ds_read_b64_tr_b16 v[106:107], v5 offset:13952
  buffer_load_dwordx4 v[204:207], v7, s[32:35], s46 offen offset:3072 sc1
  s_waitcnt vmcnt(8)
  s_waitcnt lgkmcnt(8)
  v_mfma_f32_16x16x32_bf16 v[16:19], v[88:91], v[168:171], v[16:19]
  ds_read_b64_tr_b16 v[108:109], v5 offset:9376
  v_mfma_f32_16x16x32_bf16 v[20:23], v[88:91], v[172:175], v[20:23]
  ds_read_b64_tr_b16 v[110:111], v5 offset:13984
  s_waitcnt lgkmcnt(8)
  v_mfma_f32_16x16x32_bf16 v[24:27], v[92:95], v[168:171], v[24:27]
  ds_read_b64_tr_b16 v[112:113], v5 offset:9408
  v_mfma_f32_16x16x32_bf16 v[28:31], v[92:95], v[172:175], v[28:31]
  ds_read_b64_tr_b16 v[114:115], v5 offset:14016
  s_waitcnt lgkmcnt(8)
  v_mfma_f32_16x16x32_bf16 v[32:35], v[96:99], v[168:171], v[32:35]
  ds_read_b64_tr_b16 v[116:117], v5 offset:9440
  v_mfma_f32_16x16x32_bf16 v[36:39], v[96:99], v[172:175], v[36:39]
  ds_read_b64_tr_b16 v[118:119], v5 offset:14048
  s_waitcnt lgkmcnt(8)
  v_mfma_f32_16x16x32_bf16 v[40:43], v[100:103], v[168:171], v[40:43]
  ds_read_b64_tr_b16 v[120:121], v5 offset:9472
  v_mfma_f32_16x16x32_bf16 v[44:47], v[100:103], v[172:175], v[44:47]
  ds_read_b64_tr_b16 v[122:123], v5 offset:14080
  s_waitcnt lgkmcnt(8)
  v_mfma_f32_16x16x32_bf16 v[48:51], v[104:107], v[168:171], v[48:51]
  buffer_load_dwordx4 v[208:211], v7, s[32:35], s47 offen offset:0 sc1
  v_mfma_f32_16x16x32_bf16 v[52:55], v[104:107], v[172:175], v[52:55]
  buffer_load_dwordx4 v[212:215], v7, s[32:35], s47 offen offset:1024 sc1
  s_waitcnt lgkmcnt(6)
  v_mfma_f32_16x16x32_bf16 v[56:59], v[108:111], v[168:171], v[56:59]
  ds_read_b64_tr_b16 v[88:89], v5 offset:18432
  ds_read_b64_tr_b16 v[90:91], v5 offset:23040
  v_mfma_f32_16x16x32_bf16 v[60:63], v[108:111], v[172:175], v[60:63]
  ds_read_b64_tr_b16 v[92:93], v5 offset:18464
  ds_read_b64_tr_b16 v[94:95], v5 offset:23072
  s_waitcnt lgkmcnt(8)
  v_mfma_f32_16x16x32_bf16 v[64:67], v[112:115], v[168:171], v[64:67]
  ds_read_b64_tr_b16 v[96:97], v5 offset:18496
  v_mfma_f32_16x16x32_bf16 v[68:71], v[112:115], v[172:175], v[68:71]
  ds_read_b64_tr_b16 v[98:99], v5 offset:23104
  s_waitcnt lgkmcnt(8)
  v_mfma_f32_16x16x32_bf16 v[72:75], v[116:119], v[168:171], v[72:75]
  ds_read_b64_tr_b16 v[100:101], v5 offset:18528
  v_mfma_f32_16x16x32_bf16 v[76:79], v[116:119], v[172:175], v[76:79]
  ds_read_b64_tr_b16 v[102:103], v5 offset:23136
  s_waitcnt lgkmcnt(8)
  v_mfma_f32_16x16x32_bf16 v[80:83], v[120:123], v[168:171], v[80:83]
  ds_read_b64_tr_b16 v[104:105], v5 offset:18560
  buffer_load_dwordx4 v[216:219], v7, s[32:35], s47 offen offset:2048 sc1
  v_mfma_f32_16x16x32_bf16 v[84:87], v[120:123], v[172:175], v[84:87]
  ds_read_b64_tr_b16 v[106:107], v5 offset:23168
  buffer_load_dwordx4 v[220:223], v7, s[32:35], s47 offen offset:3072 sc1
  s_add_u32 s45, s6, 3
  s_and_b32 s45, s45, 3
  s_add_u32 s45, s45, s44
  s_lshl_b32 s45, s45, 2
  s_add_u32 s45, s45, s3
  s_lshl_b32 s46, s45, 13
  s_add_u32 s47, s46, 4096
  s_waitcnt vmcnt(10)
  s_waitcnt lgkmcnt(8)
  v_mfma_f32_16x16x32_bf16 v[16:19], v[88:91], v[176:179], v[16:19]
  ds_read_b64_tr_b16 v[108:109], v5 offset:18592
  v_mfma_f32_16x16x32_bf16 v[20:23], v[88:91], v[180:183], v[20:23]
  ds_read_b64_tr_b16 v[110:111], v5 offset:23200
  s_waitcnt lgkmcnt(8)
  v_mfma_f32_16x16x32_bf16 v[24:27], v[92:95], v[176:179], v[24:27]
  ds_read_b64_tr_b16 v[112:113], v5 offset:18624
  v_mfma_f32_16x16x32_bf16 v[28:31], v[92:95], v[180:183], v[28:31]
  ds_read_b64_tr_b16 v[114:115], v5 offset:23232
  s_waitcnt lgkmcnt(8)
  v_mfma_f32_16x16x32_bf16 v[32:35], v[96:99], v[176:179], v[32:35]
  ds_read_b64_tr_b16 v[116:117], v5 offset:18656
  v_mfma_f32_16x16x32_bf16 v[36:39], v[96:99], v[180:183], v[36:39]
  ds_read_b64_tr_b16 v[118:119], v5 offset:23264
  s_waitcnt lgkmcnt(8)
  v_mfma_f32_16x16x32_bf16 v[40:43], v[100:103], v[176:179], v[40:43]
  ds_read_b64_tr_b16 v[120:121], v5 offset:18688
  v_mfma_f32_16x16x32_bf16 v[44:47], v[100:103], v[180:183], v[44:47]
  ds_read_b64_tr_b16 v[122:123], v5 offset:23296
  s_waitcnt lgkmcnt(8)
  v_mfma_f32_16x16x32_bf16 v[48:51], v[104:107], v[176:179], v[48:51]
  buffer_load_dwordx4 v[224:227], v7, s[32:35], s46 offen offset:0 sc1
  v_mfma_f32_16x16x32_bf16 v[52:55], v[104:107], v[180:183], v[52:55]
  buffer_load_dwordx4 v[228:231], v7, s[32:35], s46 offen offset:1024 sc1
  s_waitcnt lgkmcnt(6)
  v_mfma_f32_16x16x32_bf16 v[56:59], v[108:111], v[176:179], v[56:59]
  ds_read_b64_tr_b16 v[88:89], v5 offset:27648
  ds_read_b64_tr_b16 v[90:91], v5 offset:32256
  v_mfma_f32_16x16x32_bf16 v[60:63], v[108:111], v[180:183], v[60:63]
  ds_read_b64_tr_b16 v[92:93], v5 offset:27680
  ds_read_b64_tr_b16 v[94:95], v5 offset:32288
  s_waitcnt lgkmcnt(8)
  v_mfma_f32_16x16x32_bf16 v[64:67], v[112:115], v[176:179], v[64:67]
  ds_read_b64_tr_b16 v[96:97], v5 offset:27712
  v_mfma_f32_16x16x32_bf16 v[68:71], v[112:115], v[180:183], v[68:71]
  ds_read_b64_tr_b16 v[98:99], v5 offset:32320
  s_waitcnt lgkmcnt(8)
  v_mfma_f32_16x16x32_bf16 v[72:75], v[116:119], v[176:179], v[72:75]
  ds_read_b64_tr_b16 v[100:101], v5 offset:27744
  v_mfma_f32_16x16x32_bf16 v[76:79], v[116:119], v[180:183], v[76:79]
  ds_read_b64_tr_b16 v[102:103], v5 offset:32352
  s_waitcnt lgkmcnt(8)
  v_mfma_f32_16x16x32_bf16 v[80:83], v[120:123], v[176:179], v[80:83]
  ds_read_b64_tr_b16 v[104:105], v5 offset:27776
  buffer_load_dwordx4 v[232:235], v7, s[32:35], s46 offen offset:2048 sc1
  v_mfma_f32_16x16x32_bf16 v[84:87], v[120:123], v[180:183], v[84:87]
  ds_read_b64_tr_b16 v[106:107], v5 offset:32384
  buffer_load_dwordx4 v[236:239], v7, s[32:35], s46 offen offset:3072 sc1
  s_waitcnt vmcnt(12)
  s_waitcnt lgkmcnt(8)
  v_mfma_f32_16x16x32_bf16 v[16:19], v[88:91], v[184:187], v[16:19]
  ds_read_b64_tr_b16 v[108:109], v5 offset:27808
  v_mfma_f32_16x16x32_bf16 v[20:23], v[88:91], v[188:191], v[20:23]
  ds_read_b64_tr_b16 v[110:111], v5 offset:32416
  s_waitcnt lgkmcnt(8)
  v_mfma_f32_16x16x32_bf16 v[24:27], v[92:95], v[184:187], v[24:27]
  ds_read_b64_tr_b16 v[112:113], v5 offset:27840
  v_mfma_f32_16x16x32_bf16 v[28:31], v[92:95], v[188:191], v[28:31]
  ds_read_b64_tr_b16 v[114:115], v5 offset:32448
  s_waitcnt lgkmcnt(8)
  v_mfma_f32_16x16x32_bf16 v[32:35], v[96:99], v[184:187], v[32:35]
  ds_read_b64_tr_b16 v[116:117], v5 offset:27872
  v_mfma_f32_16x16x32_bf16 v[36:39], v[96:99], v[188:191], v[36:39]
  ds_read_b64_tr_b16 v[118:119], v5 offset:32480
  s_waitcnt lgkmcnt(8)
  v_mfma_f32_16x16x32_bf16 v[40:43], v[100:103], v[184:187], v[40:43]
  ds_read_b64_tr_b16 v[120:121], v5 offset:27904
  v_mfma_f32_16x16x32_bf16 v[44:47], v[100:103], v[188:191], v[44:47]
  ds_read_b64_tr_b16 v[122:123], v5 offset:32512
  s_waitcnt lgkmcnt(8)
  v_mfma_f32_16x16x32_bf16 v[48:51], v[104:107], v[184:187], v[48:51]
  buffer_load_dwordx4 v[240:243], v7, s[32:35], s47 offen offset:0 sc1
  v_mfma_f32_16x16x32_bf16 v[52:55], v[104:107], v[188:191], v[52:55]
  buffer_load_dwordx4 v[244:247], v7, s[32:35], s47 offen offset:1024 sc1
  s_waitcnt lgkmcnt(6)
  v_mfma_f32_16x16x32_bf16 v[56:59], v[108:111], v[184:187], v[56:59]
  s_barrier
  ds_read_b64_tr_b16 v[88:89], v6 offset:0
  ds_read_b64_tr_b16 v[90:91], v6 offset:4608
  v_mfma_f32_16x16x32_bf16 v[60:63], v[108:111], v[188:191], v[60:63]
  ds_read_b64_tr_b16 v[92:93], v6 offset:32
  ds_read_b64_tr_b16 v[94:95], v6 offset:4640
  s_waitcnt lgkmcnt(8)
  v_mfma_f32_16x16x32_bf16 v[64:67], v[112:115], v[184:187], v[64:67]
  ds_read_b64_tr_b16 v[96:97], v6 offset:64
  v_mfma_f32_16x16x32_bf16 v[68:71], v[112:115], v[188:191], v[68:71]
  ds_read_b64_tr_b16 v[98:99], v6 offset:4672
  s_waitcnt lgkmcnt(8)
  v_mfma_f32_16x16x32_bf16 v[72:75], v[116:119], v[184:187], v[72:75]
  ds_read_b64_tr_b16 v[100:101], v6 offset:96
  v_mfma_f32_16x16x32_bf16 v[76:79], v[116:119], v[188:191], v[76:79]
  ds_read_b64_tr_b16 v[102:103], v6 offset:4704
  s_waitcnt lgkmcnt(8)
  v_mfma_f32_16x16x32_bf16 v[80:83], v[120:123], v[184:187], v[80:83]
  ds_read_b64_tr_b16 v[104:105], v6 offset:128
  buffer_load_dwordx4 v[248:251], v7, s[32:35], s47 offen offset:2048 sc1
  v_mfma_f32_16x16x32_bf16 v[84:87], v[120:123], v[188:191], v[84:87]
  ds_read_b64_tr_b16 v[106:107], v6 offset:4736
  buffer_load_dwordx4 v[252:255], v7, s[32:35], s47 offen offset:3072 sc1
  s_waitcnt vmcnt(8)
  s_waitcnt lgkmcnt(8)
  v_mfma_f32_16x16x32_bf16 v[16:19], v[88:91], v[192:195], v[16:19]
  ds_read_b64_tr_b16 v[108:109], v6 offset:9216
  v_mfma_f32_16x16x32_bf16 v[20:23], v[88:91], v[196:199], v[20:23]
  ds_read_b64_tr_b16 v[110:111], v6 offset:13824
  s_waitcnt lgkmcnt(8)
  v_mfma_f32_16x16x32_bf16 v[24:27], v[92:95], v[192:195], v[24:27]
  ds_read_b64_tr_b16 v[112:113], v6 offset:9248
  v_mfma_f32_16x16x32_bf16 v[28:31], v[92:95], v[196:199], v[28:31]
  ds_read_b64_tr_b16 v[114:115], v6 offset:13856
  s_waitcnt lgkmcnt(8)
  v_mfma_f32_16x16x32_bf16 v[32:35], v[96:99], v[192:195], v[32:35]
  ds_read_b64_tr_b16 v[116:117], v6 offset:9280
  v_mfma_f32_16x16x32_bf16 v[36:39], v[96:99], v[196:199], v[36:39]
  ds_read_b64_tr_b16 v[118:119], v6 offset:13888
  s_waitcnt lgkmcnt(8)
  v_mfma_f32_16x16x32_bf16 v[40:43], v[100:103], v[192:195], v[40:43]
  ds_read_b64_tr_b16 v[120:121], v6 offset:9312
  v_mfma_f32_16x16x32_bf16 v[44:47], v[100:103], v[196:199], v[44:47]
  ds_read_b64_tr_b16 v[122:123], v6 offset:13920
  s_waitcnt lgkmcnt(8)
  v_mfma_f32_16x16x32_bf16 v[48:51], v[104:107], v[192:195], v[48:51]
  ds_read_b64_tr_b16 v[124:125], v6 offset:9344
  v_mfma_f32_16x16x32_bf16 v[52:55], v[104:107], v[196:199], v[52:55]
  ds_read_b64_tr_b16 v[126:127], v6 offset:13952
  s_waitcnt lgkmcnt(8)
  v_mfma_f32_16x16x32_bf16 v[16:19], v[108:111], v[200:203], v[16:19]
  ds_read_b64_tr_b16 v[88:89], v6 offset:18432
  v_mfma_f32_16x16x32_bf16 v[20:23], v[108:111], v[204:207], v[20:23]
  ds_read_b64_tr_b16 v[90:91], v6 offset:23040
  s_waitcnt lgkmcnt(8)
  v_mfma_f32_16x16x32_bf16 v[24:27], v[112:115], v[200:203], v[24:27]
  ds_read_b64_tr_b16 v[92:93], v6 offset:18464
  v_mfma_f32_16x16x32_bf16 v[28:31], v[112:115], v[204:207], v[28:31]
  ds_read_b64_tr_b16 v[94:95], v6 offset:23072
  s_waitcnt lgkmcnt(8)
  v_mfma_f32_16x16x32_bf16 v[32:35], v[116:119], v[200:203], v[32:35]
  ds_read_b64_tr_b16 v[96:97], v6 offset:18496
  v_mfma_f32_16x16x32_bf16 v[36:39], v[116:119], v[204:207], v[36:39]
  ds_read_b64_tr_b16 v[98:99], v6 offset:23104
  s_waitcnt lgkmcnt(8)
  v_mfma_f32_16x16x32_bf16 v[40:43], v[120:123], v[200:203], v[40:43]
  ds_read_b64_tr_b16 v[100:101], v6 offset:18528
  v_mfma_f32_16x16x32_bf16 v[44:47], v[120:123], v[204:207], v[44:47]
  ds_read_b64_tr_b16 v[102:103], v6 offset:23136
  s_waitcnt lgkmcnt(8)
  v_mfma_f32_16x16x32_bf16 v[48:51], v[124:127], v[200:203], v[48:51]
  ds_read_b64_tr_b16 v[104:105], v6 offset:18560
  v_mfma_f32_16x16x32_bf16 v[52:55], v[124:127], v[204:207], v[52:55]
  ds_read_b64_tr_b16 v[106:107], v6 offset:23168
  s_waitcnt lgkmcnt(8)
  v_mfma_f32_16x16x32_bf16 v[16:19], v[88:91], v[208:211], v[16:19]
  ds_read_b64_tr_b16 v[108:109], v6 offset:27648
  v_mfma_f32_16x16x32_bf16 v[20:23], v[88:91], v[212:215], v[20:23]
  ds_read_b64_tr_b16 v[110:111], v6 offset:32256
  s_waitcnt lgkmcnt(8)
  v_mfma_f32_16x16x32_bf16 v[24:27], v[92:95], v[208:211], v[24:27]
  ds_read_b64_tr_b16 v[112:113], v6 offset:27680
  v_mfma_f32_16x16x32_bf16 v[28:31], v[92:95], v[212:215], v[28:31]
  ds_read_b64_tr_b16 v[114:115], v6 offset:32288
  s_waitcnt lgkmcnt(8)
  v_mfma_f32_16x16x32_bf16 v[32:35], v[96:99], v[208:211], v[32:35]
  ds_read_b64_tr_b16 v[116:117], v6 offset:27712
  v_mfma_f32_16x16x32_bf16 v[36:39], v[96:99], v[212:215], v[36:39]
  ds_read_b64_tr_b16 v[118:119], v6 offset:32320
  s_waitcnt lgkmcnt(8)
  v_mfma_f32_16x16x32_bf16 v[40:43], v[100:103], v[208:211], v[40:43]
  ds_read_b64_tr_b16 v[120:121], v6 offset:27744
  v_mfma_f32_16x16x32_bf16 v[44:47], v[100:103], v[212:215], v[44:47]
  ds_read_b64_tr_b16 v[122:123], v6 offset:32352
  s_waitcnt lgkmcnt(8)
  v_mfma_f32_16x16x32_bf16 v[48:51], v[104:107], v[208:211], v[48:51]
  ds_read_b64_tr_b16 v[124:125], v6 offset:27776
  v_mfma_f32_16x16x32_bf16 v[52:55], v[104:107], v[212:215], v[52:55]
  ds_read_b64_tr_b16 v[126:127], v6 offset:32384
  s_waitcnt lgkmcnt(8)
  v_mfma_f32_16x16x32_bf16 v[16:19], v[108:111], v[216:219], v[16:19]
  s_barrier
  ds_read_b64_tr_b16 v[88:89], v12 offset:0
  v_mfma_f32_16x16x32_bf16 v[20:23], v[108:111], v[220:223], v[20:23]
  ds_read_b64_tr_b16 v[90:91], v12 offset:4608
  s_waitcnt lgkmcnt(8)
  v_mfma_f32_16x16x32_bf16 v[24:27], v[112:115], v[216:219], v[24:27]
  ds_read_b64_tr_b16 v[92:93], v12 offset:32
  v_mfma_f32_16x16x32_bf16 v[28:31], v[112:115], v[220:223], v[28:31]
  ds_read_b64_tr_b16 v[94:95], v12 offset:4640
  s_waitcnt lgkmcnt(8)
  v_mfma_f32_16x16x32_bf16 v[32:35], v[116:119], v[216:219], v[32:35]
  ds_read_b64_tr_b16 v[96:97], v12 offset:64
  v_mfma_f32_16x16x32_bf16 v[36:39], v[116:119], v[220:223], v[36:39]
  ds_read_b64_tr_b16 v[98:99], v12 offset:4672
  s_waitcnt lgkmcnt(8)
  v_mfma_f32_16x16x32_bf16 v[40:43], v[120:123], v[216:219], v[40:43]
  ds_read_b64_tr_b16 v[100:101], v12 offset:96
  v_mfma_f32_16x16x32_bf16 v[44:47], v[120:123], v[220:223], v[44:47]
  ds_read_b64_tr_b16 v[102:103], v12 offset:4704
  s_waitcnt lgkmcnt(8)
  v_mfma_f32_16x16x32_bf16 v[48:51], v[124:127], v[216:219], v[48:51]
  ds_read_b64_tr_b16 v[104:105], v12 offset:128
  v_mfma_f32_16x16x32_bf16 v[52:55], v[124:127], v[220:223], v[52:55]
  ds_read_b64_tr_b16 v[106:107], v12 offset:4736
  s_waitcnt vmcnt(0)
  s_waitcnt lgkmcnt(8)
  v_mfma_f32_16x16x32_bf16 v[16:19], v[88:91], v[224:227], v[16:19]
  ds_read_b64_tr_b16 v[108:109], v12 offset:9216
  v_mfma_f32_16x16x32_bf16 v[20:23], v[88:91], v[228:231], v[20:23]
  ds_read_b64_tr_b16 v[110:111], v12 offset:13824
  s_waitcnt lgkmcnt(8)
  v_mfma_f32_16x16x32_bf16 v[24:27], v[92:95], v[224:227], v[24:27]
  ds_read_b64_tr_b16 v[112:113], v12 offset:9248
  v_mfma_f32_16x16x32_bf16 v[28:31], v[92:95], v[228:231], v[28:31]
  ds_read_b64_tr_b16 v[114:115], v12 offset:13856
  s_waitcnt lgkmcnt(8)
  v_mfma_f32_16x16x32_bf16 v[32:35], v[96:99], v[224:227], v[32:35]
  ds_read_b64_tr_b16 v[116:117], v12 offset:9280
  v_mfma_f32_16x16x32_bf16 v[36:39], v[96:99], v[228:231], v[36:39]
  ds_read_b64_tr_b16 v[118:119], v12 offset:13888
  s_waitcnt lgkmcnt(8)
  v_mfma_f32_16x16x32_bf16 v[40:43], v[100:103], v[224:227], v[40:43]
  ds_read_b64_tr_b16 v[120:121], v12 offset:9312
  v_mfma_f32_16x16x32_bf16 v[44:47], v[100:103], v[228:231], v[44:47]
  ds_read_b64_tr_b16 v[122:123], v12 offset:13920
  s_waitcnt lgkmcnt(8)
  v_mfma_f32_16x16x32_bf16 v[48:51], v[104:107], v[224:227], v[48:51]
  ds_read_b64_tr_b16 v[124:125], v12 offset:9344
  v_mfma_f32_16x16x32_bf16 v[52:55], v[104:107], v[228:231], v[52:55]
  ds_read_b64_tr_b16 v[126:127], v12 offset:13952
  s_waitcnt lgkmcnt(8)
  v_mfma_f32_16x16x32_bf16 v[16:19], v[108:111], v[232:235], v[16:19]
  ds_read_b64_tr_b16 v[88:89], v12 offset:18432
  v_mfma_f32_16x16x32_bf16 v[20:23], v[108:111], v[236:239], v[20:23]
  ds_read_b64_tr_b16 v[90:91], v12 offset:23040
  s_waitcnt lgkmcnt(8)
  v_mfma_f32_16x16x32_bf16 v[24:27], v[112:115], v[232:235], v[24:27]
  ds_read_b64_tr_b16 v[92:93], v12 offset:18464
  v_mfma_f32_16x16x32_bf16 v[28:31], v[112:115], v[236:239], v[28:31]
  ds_read_b64_tr_b16 v[94:95], v12 offset:23072
  s_waitcnt lgkmcnt(8)
  v_mfma_f32_16x16x32_bf16 v[32:35], v[116:119], v[232:235], v[32:35]
  ds_read_b64_tr_b16 v[96:97], v12 offset:18496
  v_mfma_f32_16x16x32_bf16 v[36:39], v[116:119], v[236:239], v[36:39]
  ds_read_b64_tr_b16 v[98:99], v12 offset:23104
  s_waitcnt lgkmcnt(8)
  v_mfma_f32_16x16x32_bf16 v[40:43], v[120:123], v[232:235], v[40:43]
  ds_read_b64_tr_b16 v[100:101], v12 offset:18528
  v_mfma_f32_16x16x32_bf16 v[44:47], v[120:123], v[236:239], v[44:47]
  ds_read_b64_tr_b16 v[102:103], v12 offset:23136
  s_waitcnt lgkmcnt(8)
  v_mfma_f32_16x16x32_bf16 v[48:51], v[124:127], v[232:235], v[48:51]
  ds_read_b64_tr_b16 v[104:105], v12 offset:18560
  v_mfma_f32_16x16x32_bf16 v[52:55], v[124:127], v[236:239], v[52:55]
  ds_read_b64_tr_b16 v[106:107], v12 offset:23168
  s_waitcnt lgkmcnt(8)
  v_mfma_f32_16x16x32_bf16 v[16:19], v[88:91], v[240:243], v[16:19]
  ds_read_b64_tr_b16 v[108:109], v12 offset:27648
  v_mfma_f32_16x16x32_bf16 v[20:23], v[88:91], v[244:247], v[20:23]
  ds_read_b64_tr_b16 v[110:111], v12 offset:32256
  s_waitcnt lgkmcnt(8)
  v_mfma_f32_16x16x32_bf16 v[24:27], v[92:95], v[240:243], v[24:27]
  ds_read_b64_tr_b16 v[112:113], v12 offset:27680
  v_mfma_f32_16x16x32_bf16 v[28:31], v[92:95], v[244:247], v[28:31]
  ds_read_b64_tr_b16 v[114:115], v12 offset:32288
  s_waitcnt lgkmcnt(8)
  v_mfma_f32_16x16x32_bf16 v[32:35], v[96:99], v[240:243], v[32:35]
  ds_read_b64_tr_b16 v[116:117], v12 offset:27712
  v_mfma_f32_16x16x32_bf16 v[36:39], v[96:99], v[244:247], v[36:39]
  ds_read_b64_tr_b16 v[118:119], v12 offset:32320
  s_waitcnt lgkmcnt(8)
  v_mfma_f32_16x16x32_bf16 v[40:43], v[100:103], v[240:243], v[40:43]
  ds_read_b64_tr_b16 v[120:121], v12 offset:27744
  v_mfma_f32_16x16x32_bf16 v[44:47], v[100:103], v[244:247], v[44:47]
  ds_read_b64_tr_b16 v[122:123], v12 offset:32352
  s_waitcnt lgkmcnt(8)
  v_mfma_f32_16x16x32_bf16 v[48:51], v[104:107], v[240:243], v[48:51]
  ds_read_b64_tr_b16 v[124:125], v12 offset:27776
  v_mfma_f32_16x16x32_bf16 v[52:55], v[104:107], v[244:247], v[52:55]
  ds_read_b64_tr_b16 v[126:127], v12 offset:32384
  s_waitcnt lgkmcnt(8)
  v_mfma_f32_16x16x32_bf16 v[16:19], v[108:111], v[248:251], v[16:19]
  ds_read_b64_tr_b16 v[88:89], v6 offset:160
  v_mfma_f32_16x16x32_bf16 v[20:23], v[108:111], v[252:255], v[20:23]
  ds_read_b64_tr_b16 v[90:91], v6 offset:4768
  s_waitcnt lgkmcnt(8)
  v_mfma_f32_16x16x32_bf16 v[24:27], v[112:115], v[248:251], v[24:27]
  ds_read_b64_tr_b16 v[92:93], v6 offset:192
  v_mfma_f32_16x16x32_bf16 v[28:31], v[112:115], v[252:255], v[28:31]
  ds_read_b64_tr_b16 v[94:95], v6 offset:4800
  s_waitcnt lgkmcnt(8)
  v_mfma_f32_16x16x32_bf16 v[32:35], v[116:119], v[248:251], v[32:35]
  ds_read_b64_tr_b16 v[96:97], v6 offset:224
  v_mfma_f32_16x16x32_bf16 v[36:39], v[116:119], v[252:255], v[36:39]
  ds_read_b64_tr_b16 v[98:99], v6 offset:4832
  s_waitcnt lgkmcnt(8)
  v_mfma_f32_16x16x32_bf16 v[40:43], v[120:123], v[248:251], v[40:43]
  ds_read_b64_tr_b16 v[100:101], v6 offset:256
  v_mfma_f32_16x16x32_bf16 v[44:47], v[120:123], v[252:255], v[44:47]
  ds_read_b64_tr_b16 v[102:103], v6 offset:4864
  s_waitcnt lgkmcnt(8)
  v_mfma_f32_16x16x32_bf16 v[48:51], v[124:127], v[248:251], v[48:51]
  v_mfma_f32_16x16x32_bf16 v[52:55], v[124:127], v[252:255], v[52:55]
  s_waitcnt lgkmcnt(6)
  v_mfma_f32_16x16x32_bf16 v[56:59], v[88:91], v[192:195], v[56:59]
  ds_read_b64_tr_b16 v[108:109], v6 offset:9376
  v_mfma_f32_16x16x32_bf16 v[60:63], v[88:91], v[196:199], v[60:63]
  ds_read_b64_tr_b16 v[110:111], v6 offset:13984
  s_waitcnt lgkmcnt(6)
  v_mfma_f32_16x16x32_bf16 v[64:67], v[92:95], v[192:195], v[64:67]
  ds_read_b64_tr_b16 v[112:113], v6 offset:9408
  v_mfma_f32_16x16x32_bf16 v[68:71], v[92:95], v[196:199], v[68:71]
  ds_read_b64_tr_b16 v[114:115], v6 offset:14016
  s_waitcnt lgkmcnt(6)
  v_mfma_f32_16x16x32_bf16 v[72:75], v[96:99], v[192:195], v[72:75]
  ds_read_b64_tr_b16 v[116:117], v6 offset:9440
  v_mfma_f32_16x16x32_bf16 v[76:79], v[96:99], v[196:199], v[76:79]
  ds_read_b64_tr_b16 v[118:119], v6 offset:14048
  s_waitcnt lgkmcnt(6)
  v_mfma_f32_16x16x32_bf16 v[80:83], v[100:103], v[192:195], v[80:83]
  ds_read_b64_tr_b16 v[120:121], v6 offset:9472
  v_mfma_f32_16x16x32_bf16 v[84:87], v[100:103], v[196:199], v[84:87]
  ds_read_b64_tr_b16 v[122:123], v6 offset:14080
  s_waitcnt lgkmcnt(6)
  v_mfma_f32_16x16x32_bf16 v[56:59], v[108:111], v[200:203], v[56:59]
  ds_read_b64_tr_b16 v[88:89], v6 offset:18592
  v_cvt_pk_bf16_f32 v160, v16, v17
  v_cvt_pk_bf16_f32 v161, v18, v19
  v_mfma_f32_16x16x32_bf16 v[60:63], v[108:111], v[204:207], v[60:63]
  ds_read_b64_tr_b16 v[90:91], v6 offset:23200
  v_cvt_pk_bf16_f32 v162, v20, v21
  v_cvt_pk_bf16_f32 v163, v22, v23
  s_waitcnt lgkmcnt(6)
  v_mfma_f32_16x16x32_bf16 v[64:67], v[112:115], v[200:203], v[64:67]
  ds_read_b64_tr_b16 v[92:93], v6 offset:18624
  buffer_store_dwordx4 v[160:163], v13, s[32:35], s40 offen offset:0 sc1
  v_cvt_pk_bf16_f32 v164, v24, v25
  v_mfma_f32_16x16x32_bf16 v[68:71], v[112:115], v[204:207], v[68:71]
  ds_read_b64_tr_b16 v[94:95], v6 offset:23232
  v_cvt_pk_bf16_f32 v165, v26, v27
  v_cvt_pk_bf16_f32 v166, v28, v29
  s_waitcnt lgkmcnt(6)
  v_mfma_f32_16x16x32_bf16 v[72:75], v[116:119], v[200:203], v[72:75]
  ds_read_b64_tr_b16 v[96:97], v6 offset:18656
  v_cvt_pk_bf16_f32 v167, v30, v31
  buffer_store_dwordx4 v[164:167], v13, s[32:35], s40 offen offset:128 sc1
  v_mfma_f32_16x16x32_bf16 v[76:79], v[116:119], v[204:207], v[76:79]
  ds_read_b64_tr_b16 v[98:99], v6 offset:23264
  s_waitcnt lgkmcnt(6)
  v_mfma_f32_16x16x32_bf16 v[80:83], v[120:123], v[200:203], v[80:83]
  ds_read_b64_tr_b16 v[100:101], v6 offset:18688
  v_mfma_f32_16x16x32_bf16 v[84:87], v[120:123], v[204:207], v[84:87]
  ds_read_b64_tr_b16 v[102:103], v6 offset:23296
  s_waitcnt lgkmcnt(6)
  v_mfma_f32_16x16x32_bf16 v[56:59], v[88:91], v[208:211], v[56:59]
  ds_read_b64_tr_b16 v[108:109], v6 offset:27808
  v_cvt_pk_bf16_f32 v168, v32, v33
  v_cvt_pk_bf16_f32 v169, v34, v35
  v_mfma_f32_16x16x32_bf16 v[60:63], v[88:91], v[212:215], v[60:63]
  ds_read_b64_tr_b16 v[110:111], v6 offset:32416
  v_cvt_pk_bf16_f32 v170, v36, v37
  v_cvt_pk_bf16_f32 v171, v38, v39
  s_waitcnt lgkmcnt(6)
  v_mfma_f32_16x16x32_bf16 v[64:67], v[92:95], v[208:211], v[64:67]
  ds_read_b64_tr_b16 v[112:113], v6 offset:27840
  buffer_store_dwordx4 v[168:171], v13, s[32:35], s40 offen offset:256 sc1
  v_cvt_pk_bf16_f32 v172, v40, v41
  v_mfma_f32_16x16x32_bf16 v[68:71], v[92:95], v[212:215], v[68:71]
  ds_read_b64_tr_b16 v[114:115], v6 offset:32448
  v_cvt_pk_bf16_f32 v173, v42, v43
  v_cvt_pk_bf16_f32 v174, v44, v45
  s_waitcnt lgkmcnt(6)
  v_mfma_f32_16x16x32_bf16 v[72:75], v[96:99], v[208:211], v[72:75]
  ds_read_b64_tr_b16 v[116:117], v6 offset:27872
  v_cvt_pk_bf16_f32 v175, v46, v47
  buffer_store_dwordx4 v[172:175], v13, s[32:35], s40 offen offset:384 sc1
  v_mfma_f32_16x16x32_bf16 v[76:79], v[96:99], v[212:215], v[76:79]
  ds_read_b64_tr_b16 v[118:119], v6 offset:32480
  s_waitcnt lgkmcnt(6)
  v_mfma_f32_16x16x32_bf16 v[80:83], v[100:103], v[208:211], v[80:83]
  ds_read_b64_tr_b16 v[120:121], v6 offset:27904
  v_mfma_f32_16x16x32_bf16 v[84:87], v[100:103], v[212:215], v[84:87]
  ds_read_b64_tr_b16 v[122:123], v6 offset:32512
  s_waitcnt lgkmcnt(6)
  v_mfma_f32_16x16x32_bf16 v[56:59], v[108:111], v[216:219], v[56:59]
  ds_read_b64_tr_b16 v[88:89], v12 offset:160
  v_cvt_pk_bf16_f32 v176, v48, v49
  v_mfma_f32_16x16x32_bf16 v[60:63], v[108:111], v[220:223], v[60:63]
  ds_read_b64_tr_b16 v[90:91], v12 offset:4768
  v_cvt_pk_bf16_f32 v177, v50, v51
  s_waitcnt lgkmcnt(6)
  v_mfma_f32_16x16x32_bf16 v[64:67], v[112:115], v[216:219], v[64:67]
  ds_read_b64_tr_b16 v[92:93], v12 offset:192
  v_cvt_pk_bf16_f32 v178, v52, v53
  v_mfma_f32_16x16x32_bf16 v[68:71], v[112:115], v[220:223], v[68:71]
  ds_read_b64_tr_b16 v[94:95], v12 offset:4800
  v_cvt_pk_bf16_f32 v179, v54, v55
  s_waitcnt lgkmcnt(6)
  v_mfma_f32_16x16x32_bf16 v[72:75], v[116:119], v[216:219], v[72:75]
  ds_read_b64_tr_b16 v[96:97], v12 offset:224
  buffer_store_dwordx4 v[176:179], v13, s[32:35], s40 offen offset:512 sc1
  v_mfma_f32_16x16x32_bf16 v[76:79], v[116:119], v[220:223], v[76:79]
  ds_read_b64_tr_b16 v[98:99], v12 offset:4832
  s_waitcnt lgkmcnt(6)
  v_mfma_f32_16x16x32_bf16 v[80:83], v[120:123], v[216:219], v[80:83]
  ds_read_b64_tr_b16 v[100:101], v12 offset:256
  v_mfma_f32_16x16x32_bf16 v[84:87], v[120:123], v[220:223], v[84:87]
  ds_read_b64_tr_b16 v[102:103], v12 offset:4864
  s_waitcnt lgkmcnt(6)
  v_mfma_f32_16x16x32_bf16 v[56:59], v[88:91], v[224:227], v[56:59]
  ds_read_b64_tr_b16 v[108:109], v12 offset:9376
  v_mfma_f32_16x16x32_bf16 v[60:63], v[88:91], v[228:231], v[60:63]
  ds_read_b64_tr_b16 v[110:111], v12 offset:13984
  s_waitcnt lgkmcnt(6)
  v_mfma_f32_16x16x32_bf16 v[64:67], v[92:95], v[224:227], v[64:67]
  ds_read_b64_tr_b16 v[112:113], v12 offset:9408
  v_mfma_f32_16x16x32_bf16 v[68:71], v[92:95], v[228:231], v[68:71]
  ds_read_b64_tr_b16 v[114:115], v12 offset:14016
  s_waitcnt lgkmcnt(6)
  v_mfma_f32_16x16x32_bf16 v[72:75], v[96:99], v[224:227], v[72:75]
  ds_read_b64_tr_b16 v[116:117], v12 offset:9440
  v_mfma_f32_16x16x32_bf16 v[76:79], v[96:99], v[228:231], v[76:79]
  ds_read_b64_tr_b16 v[118:119], v12 offset:14048
  s_waitcnt lgkmcnt(6)
  v_mfma_f32_16x16x32_bf16 v[80:83], v[100:103], v[224:227], v[80:83]
  ds_read_b64_tr_b16 v[120:121], v12 offset:9472
  v_mfma_f32_16x16x32_bf16 v[84:87], v[100:103], v[228:231], v[84:87]
  ds_read_b64_tr_b16 v[122:123], v12 offset:14080
  s_waitcnt lgkmcnt(6)
  v_mfma_f32_16x16x32_bf16 v[56:59], v[108:111], v[232:235], v[56:59]
  ds_read_b64_tr_b16 v[88:89], v12 offset:18592
  v_mfma_f32_16x16x32_bf16 v[60:63], v[108:111], v[236:239], v[60:63]
  ds_read_b64_tr_b16 v[90:91], v12 offset:23200
  s_waitcnt lgkmcnt(6)
  v_mfma_f32_16x16x32_bf16 v[64:67], v[112:115], v[232:235], v[64:67]
  ds_read_b64_tr_b16 v[92:93], v12 offset:18624
  v_mfma_f32_16x16x32_bf16 v[68:71], v[112:115], v[236:239], v[68:71]
  ds_read_b64_tr_b16 v[94:95], v12 offset:23232
  s_waitcnt lgkmcnt(6)
  v_mfma_f32_16x16x32_bf16 v[72:75], v[116:119], v[232:235], v[72:75]
  ds_read_b64_tr_b16 v[96:97], v12 offset:18656
  v_mfma_f32_16x16x32_bf16 v[76:79], v[116:119], v[236:239], v[76:79]
  ds_read_b64_tr_b16 v[98:99], v12 offset:23264
  s_waitcnt lgkmcnt(6)
  v_mfma_f32_16x16x32_bf16 v[80:83], v[120:123], v[232:235], v[80:83]
  ds_read_b64_tr_b16 v[100:101], v12 offset:18688
  v_mfma_f32_16x16x32_bf16 v[84:87], v[120:123], v[236:239], v[84:87]
  ds_read_b64_tr_b16 v[102:103], v12 offset:23296
  s_waitcnt lgkmcnt(6)
  v_mfma_f32_16x16x32_bf16 v[56:59], v[88:91], v[240:243], v[56:59]
  ds_read_b64_tr_b16 v[108:109], v12 offset:27808
  v_mfma_f32_16x16x32_bf16 v[60:63], v[88:91], v[244:247], v[60:63]
  ds_read_b64_tr_b16 v[110:111], v12 offset:32416
  s_waitcnt lgkmcnt(6)
  v_mfma_f32_16x16x32_bf16 v[64:67], v[92:95], v[240:243], v[64:67]
  ds_read_b64_tr_b16 v[112:113], v12 offset:27840
  v_mfma_f32_16x16x32_bf16 v[68:71], v[92:95], v[244:247], v[68:71]
  ds_read_b64_tr_b16 v[114:115], v12 offset:32448
  s_waitcnt lgkmcnt(6)
  v_mfma_f32_16x16x32_bf16 v[72:75], v[96:99], v[240:243], v[72:75]
  ds_read_b64_tr_b16 v[116:117], v12 offset:27872
  v_mfma_f32_16x16x32_bf16 v[76:79], v[96:99], v[244:247], v[76:79]
  ds_read_b64_tr_b16 v[118:119], v12 offset:32480
  s_waitcnt lgkmcnt(6)
  v_mfma_f32_16x16x32_bf16 v[80:83], v[100:103], v[240:243], v[80:83]
  ds_read_b64_tr_b16 v[120:121], v12 offset:27904
  v_mfma_f32_16x16x32_bf16 v[84:87], v[100:103], v[244:247], v[84:87]
  ds_read_b64_tr_b16 v[122:123], v12 offset:32512
  s_waitcnt lgkmcnt(6)
  v_mfma_f32_16x16x32_bf16 v[56:59], v[108:111], v[248:251], v[56:59]
  v_mfma_f32_16x16x32_bf16 v[60:63], v[108:111], v[252:255], v[60:63]
  s_waitcnt lgkmcnt(4)
  v_mfma_f32_16x16x32_bf16 v[64:67], v[112:115], v[248:251], v[64:67]
  v_mfma_f32_16x16x32_bf16 v[68:71], v[112:115], v[252:255], v[68:71]
  s_waitcnt lgkmcnt(2)
  v_mfma_f32_16x16x32_bf16 v[72:75], v[116:119], v[248:251], v[72:75]
  v_mfma_f32_16x16x32_bf16 v[76:79], v[116:119], v[252:255], v[76:79]
  s_waitcnt lgkmcnt(0)
  v_mfma_f32_16x16x32_bf16 v[80:83], v[120:123], v[248:251], v[80:83]
  v_mfma_f32_16x16x32_bf16 v[84:87], v[120:123], v[252:255], v[84:87]
  s_nop 7
  v_cvt_pk_bf16_f32 v180, v56, v57
  v_cvt_pk_bf16_f32 v181, v58, v59
  v_cvt_pk_bf16_f32 v182, v60, v61
  v_cvt_pk_bf16_f32 v183, v62, v63
  buffer_store_dwordx4 v[180:183], v13, s[32:35], s40 offen offset:640 sc1
  v_cvt_pk_bf16_f32 v184, v64, v65
  v_cvt_pk_bf16_f32 v185, v66, v67
  v_cvt_pk_bf16_f32 v186, v68, v69
  v_cvt_pk_bf16_f32 v187, v70, v71
  buffer_store_dwordx4 v[184:187], v13, s[32:35], s40 offen offset:768 sc1
  v_cvt_pk_bf16_f32 v188, v72, v73
  v_cvt_pk_bf16_f32 v189, v74, v75
  v_cvt_pk_bf16_f32 v190, v76, v77
  v_cvt_pk_bf16_f32 v191, v78, v79
  buffer_store_dwordx4 v[188:191], v13, s[32:35], s40 offen offset:896 sc1
  v_cvt_pk_bf16_f32 v192, v80, v81
  v_cvt_pk_bf16_f32 v193, v82, v83
  v_cvt_pk_bf16_f32 v194, v84, v85
  v_cvt_pk_bf16_f32 v195, v86, v87
  buffer_store_dwordx4 v[192:195], v13, s[32:35], s40 offen offset:1024 sc1
  s_lshl_b32 s48, s58, 8
  s_add_u32 s48, s48, 29884416
  s_lshl_b32 s49, s4, 3
  s_add_u32 s49, s49, s48
  s_waitcnt vmcnt(4)
  v_mov_b32 v10, s52
  v_mov_b32 v11, s53
  s_mov_b64 exec, 1
  buffer_store_dwordx2 v[10:11], v9, s[32:35], s49 offen sc1
  s_mov_b64 exec, -1
  s_add_u32 s49, s49, 128
  v_and_b32 v8, 7, v0
  v_lshlrev_b32 v8, 3, v8
  v_and_b32 v14, 1, v0
  v_mul_u32_u24 v14, 1152, v14
  v_bfe_u32 v15, v0, 1, 2
  v_lshl_add_u32 v14, v15, 3, v14
  v_lshrrev_b32 v12, 3, v0
  v_lshl_add_u32 v14, v12, 5, v14
  v_add_u32 v15, 160, v14
  s_mov_b32 s36, s26
  s_and_b32 s37, s27, 0xffff
  s_mov_b32 s38, 1179648
  s_mov_b32 s39, 0x00020000
  s_lshl_b32 s56, s9, 2
  s_add_u32 s56, s56, s3
  s_lshl_b32 s56, s56, 5
  s_lshl_b32 s57, s4, 1
  s_add_u32 s56, s56, s57
  s_mul_i32 s56, s56, 1152
  s_mul_i32 s57, s6, 288
  s_add_u32 s56, s56, s57
  s_add_u32 s57, s56, 18432
  s_mul_i32 s47, s4, 9216
  s_add_u32 s47, s47, s59
  s_waitcnt vmcnt(1)
  v_mov_b32 v10, s52
  v_mov_b32 v11, s53
  s_mov_b64 exec, 1
  buffer_store_dwordx2 v[10:11], v9, s[32:35], s49 offen sc1
  s_mov_b64 exec, -1
  s_mov_b32 s50, 0
L_poll_da:
  s_sleep 1
  buffer_load_dwordx2 v[10:11], v8, s[32:35], s48 offen sc1
  s_add_u32 s50, s50, 1
  s_waitcnt vmcnt(0)
  v_cmp_eq_u64 vcc, v[10:11], s[52:53]
  s_cmp_ge_u32 s50, 200000
  s_cbranch_scc1 L_poll_da_done
  s_cmp_eq_u64 vcc, -1
  s_cbranch_scc0 L_poll_da
L_poll_da_done:
  s_mov_b32 s46, s47
  s_mov_b32 exec_hi, 0xff
  buffer_load_dwordx4 v[196:199], v7, s[32:35], s46 offen sc1
  s_add_u32 s46, s46, 1152
  buffer_load_dwordx4 v[200:203], v7, s[32:35], s46 offen sc1
  s_add_u32 s46, s46, 1152
  buffer_load_dwordx4 v[204:207], v7, s[32:35], s46 offen sc1
  s_add_u32 s46, s46, 1152
  buffer_load_dwordx4 v[208:211], v7, s[32:35], s46 offen sc1
  s_add_u32 s46, s46, 1152
  buffer_load_dwordx4 v[212:215], v7, s[32:35], s46 offen sc1
  s_add_u32 s46, s46, 1152
  buffer_load_dwordx4 v[216:219], v7, s[32:35], s46 offen sc1
  s_add_u32 s46, s46, 1152
  buffer_load_dwordx4 v[220:223], v7, s[32:35], s46 offen sc1
  s_add_u32 s46, s46, 1152
  buffer_load_dwordx4 v[224:227], v7, s[32:35], s46 offen sc1
  s_mov_b64 exec, -1
  s_add_u32 s48, s48, 128
  s_mov_b32 s50, 0
L_poll_db:
  buffer_load_dwordx2 v[10:11], v8, s[32:35], s48 offen sc1
  s_add_u32 s50, s50, 1
  s_waitcnt vmcnt(0)
  v_cmp_eq_u64 vcc, v[10:11], s[52:53]
  s_cmp_ge_u32 s50, 200000
  s_cbranch_scc1 L_poll_db_done
  s_cmp_eq_u64 vcc, -1
  s_cbranch_scc0 L_poll_db
L_poll_db_done:
  s_mov_b64 exec, 0xffffffff
  buffer_load_dwordx4 v[88:91], v7, s[32:35], s47 offen offset:640 sc1
  s_add_u32 s47, s47, 1152
  buffer_load_dwordx4 v[92:95], v7, s[32:35], s47 offen offset:640 sc1
  s_add_u32 s47, s47, 1152
  buffer_load_dwordx4 v[96:99], v7, s[32:35], s47 offen offset:640 sc1
  s_add_u32 s47, s47, 1152
  buffer_load_dwordx4 v[100:103], v7, s[32:35], s47 offen offset:640 sc1
  s_add_u32 s47, s47, 1152
  buffer_load_dwordx4 v[104:107], v7, s[32:35], s47 offen offset:640 sc1
  s_add_u32 s47, s47, 1152
  buffer_load_dwordx4 v[108:111], v7, s[32:35], s47 offen offset:640 sc1
  s_add_u32 s47, s47, 1152
  buffer_load_dwordx4 v[112:115], v7, s[32:35], s47 offen offset:640 sc1
  s_add_u32 s47, s47, 1152
  buffer_load_dwordx4 v[116:119], v7, s[32:35], s47 offen offset:640 sc1
  s_mov_b64 exec, -1
  v_lshlrev_b32 v16, 16, v196
  v_and_b32 v17, 0xffff0000, v196
  v_lshlrev_b32 v18, 16, v197
  v_and_b32 v19, 0xffff0000, v197
  v_lshlrev_b32 v20, 16, v198
  v_and_b32 v21, 0xffff0000, v198
  v_lshlrev_b32 v22, 16, v199
  v_and_b32 v23, 0xffff0000, v199
  v_lshlrev_b32 v32, 16, v200
  v_and_b32 v33, 0xffff0000, v200
  v_pk_add_f32 v[16:17], v[16:17], v[32:33]
  v_lshlrev_b32 v34, 16, v201
  v_and_b32 v35, 0xffff0000, v201
  v_pk_add_f32 v[18:19], v[18:19], v[34:35]
  v_lshlrev_b32 v32, 16, v202
  v_and_b32 v33, 0xffff0000, v202
  v_pk_add_f32 v[20:21], v[20:21], v[32:33]
  v_lshlrev_b32 v34, 16, v203
  v_and_b32 v35, 0xffff0000, v203
  v_pk_add_f32 v[22:23], v[22:23], v[34:35]
  v_lshlrev_b32 v32, 16, v204
  v_and_b32 v33, 0xffff0000, v204
  v_pk_add_f32 v[16:17], v[16:17], v[32:33]
  v_lshlrev_b32 v34, 16, v205
  v_and_b32 v35, 0xffff0000, v205
  v_pk_add_f32 v[18:19], v[18:19], v[34:35]
  v_lshlrev_b32 v32, 16, v206
  v_and_b32 v33, 0xffff0000, v206
  v_pk_add_f32 v[20:21], v[20:21], v[32:33]
  v_lshlrev_b32 v34, 16, v207
  v_and_b32 v35, 0xffff0000, v207
  v_pk_add_f32 v[22:23], v[22:23], v[34:35]
  v_lshlrev_b32 v32, 16, v208
  v_and_b32 v33, 0xffff0000, v208
  v_pk_add_f32 v[16:17], v[16:17], v[32:33]
  v_lshlrev_b32 v34, 16, v209
  v_and_b32 v35, 0xffff0000, v209
  v_pk_add_f32 v[18:19], v[18:19], v[34:35]
  v_lshlrev_b32 v32, 16, v210
  v_and_b32 v33, 0xffff0000, v210
  v_pk_add_f32 v[20:21], v[20:21], v[32:33]
  v_lshlrev_b32 v34, 16, v211
  v_and_b32 v35, 0xffff0000, v211
  v_pk_add_f32 v[22:23], v[22:23], v[34:35]
  v_lshlrev_b32 v32, 16, v212
  v_and_b32 v33, 0xffff0000, v212
  v_pk_add_f32 v[16:17], v[16:17], v[32:33]
  v_lshlrev_b32 v34, 16, v213
  v_and_b32 v35, 0xffff0000, v213
  v_pk_add_f32 v[18:19], v[18:19], v[34:35]
  v_lshlrev_b32 v32, 16, v214
  v_and_b32 v33, 0xffff0000, v214
  v_pk_add_f32 v[20:21], v[20:21], v[32:33]
  v_lshlrev_b32 v34, 16, v215
  v_and_b32 v35, 0xffff0000, v215
  v_pk_add_f32 v[22:23], v[22:23], v[34:35]
  v_lshlrev_b32 v32, 16, v216
  v_and_b32 v33, 0xffff0000, v216
  v_pk_add_f32 v[16:17], v[16:17], v[32:33]
  v_lshlrev_b32 v34, 16, v217
  v_and_b32 v35, 0xffff0000, v217
  v_pk_add_f32 v[18:19], v[18:19], v[34:35]
  v_lshlrev_b32 v32, 16, v218
  v_and_b32 v33, 0xffff0000, v218
  v_pk_add_f32 v[20:21], v[20:21], v[32:33]
  v_lshlrev_b32 v34, 16, v219
  v_and_b32 v35, 0xffff0000, v219
  v_pk_add_f32 v[22:23], v[22:23], v[34:35]
  v_lshlrev_b32 v32, 16, v220
  v_and_b32 v33, 0xffff0000, v220
  v_pk_add_f32 v[16:17], v[16:17], v[32:33]
  v_lshlrev_b32 v34, 16, v221
  v_and_b32 v35, 0xffff0000, v221
  v_pk_add_f32 v[18:19], v[18:19], v[34:35]
  v_lshlrev_b32 v32, 16, v222
  v_and_b32 v33, 0xffff0000, v222
  v_pk_add_f32 v[20:21], v[20:21], v[32:33]
  v_lshlrev_b32 v34, 16, v223
  v_and_b32 v35, 0xffff0000, v223
  v_pk_add_f32 v[22:23], v[22:23], v[34:35]
  v_lshlrev_b32 v32, 16, v224
  v_and_b32 v33, 0xffff0000, v224
  v_pk_add_f32 v[16:17], v[16:17], v[32:33]
  v_lshlrev_b32 v34, 16, v225
  v_and_b32 v35, 0xffff0000, v225
  v_pk_add_f32 v[18:19], v[18:19], v[34:35]
  v_lshlrev_b32 v32, 16, v226
  v_and_b32 v33, 0xffff0000, v226
  v_pk_add_f32 v[20:21], v[20:21], v[32:33]
  v_lshlrev_b32 v34, 16, v227
  v_and_b32 v35, 0xffff0000, v227
  v_pk_add_f32 v[22:23], v[22:23], v[34:35]
  v_cvt_pk_bf16_f32 v36, v16, v17
  v_cvt_pk_bf16_f32 v37, v18, v19
  v_cvt_pk_bf16_f32 v38, v20, v21
  v_cvt_pk_bf16_f32 v39, v22, v23
  s_waitcnt vmcnt(7)
  v_lshlrev_b32 v24, 16, v88
  v_and_b32 v25, 0xffff0000, v88
  v_lshlrev_b32 v26, 16, v89
  v_and_b32 v27, 0xffff0000, v89
  v_lshlrev_b32 v28, 16, v90
  v_and_b32 v29, 0xffff0000, v90
  v_lshlrev_b32 v30, 16, v91
  v_and_b32 v31, 0xffff0000, v91
  s_waitcnt vmcnt(6)
  v_lshlrev_b32 v32, 16, v92
  v_and_b32 v33, 0xffff0000, v92
  v_pk_add_f32 v[24:25], v[24:25], v[32:33]
  v_lshlrev_b32 v34, 16, v93
  v_and_b32 v35, 0xffff0000, v93
  v_pk_add_f32 v[26:27], v[26:27], v[34:35]
  v_lshlrev_b32 v32, 16, v94
  v_and_b32 v33, 0xffff0000, v94
  v_pk_add_f32 v[28:29], v[28:29], v[32:33]
  v_lshlrev_b32 v34, 16, v95
  v_and_b32 v35, 0xffff0000, v95
  v_pk_add_f32 v[30:31], v[30:31], v[34:35]
  s_waitcnt vmcnt(5)
  v_lshlrev_b32 v32, 16, v96
  v_and_b32 v33, 0xffff0000, v96
  v_pk_add_f32 v[24:25], v[24:25], v[32:33]
  v_lshlrev_b32 v34, 16, v97
  v_and_b32 v35, 0xffff0000, v97
  v_pk_add_f32 v[26:27], v[26:27], v[34:35]
  v_lshlrev_b32 v32, 16, v98
  v_and_b32 v33, 0xffff0000, v98
  v_pk_add_f32 v[28:29], v[28:29], v[32:33]
  v_lshlrev_b32 v34, 16, v99
  v_and_b32 v35, 0xffff0000, v99
  v_pk_add_f32 v[30:31], v[30:31], v[34:35]
  s_waitcnt vmcnt(4)
  v_lshlrev_b32 v32, 16, v100
  v_and_b32 v33, 0xffff0000, v100
  v_pk_add_f32 v[24:25], v[24:25], v[32:33]
  v_lshlrev_b32 v34, 16, v101
  v_and_b32 v35, 0xffff0000, v101
  v_pk_add_f32 v[26:27], v[26:27], v[34:35]
  v_lshlrev_b32 v32, 16, v102
  v_and_b32 v33, 0xffff0000, v102
  v_pk_add_f32 v[28:29], v[28:29], v[32:33]
  v_lshlrev_b32 v34, 16, v103
  v_and_b32 v35, 0xffff0000, v103
  v_pk_add_f32 v[30:31], v[30:31], v[34:35]
  s_waitcnt vmcnt(3)
  v_lshlrev_b32 v32, 16, v104
  v_and_b32 v33, 0xffff0000, v104
  v_pk_add_f32 v[24:25], v[24:25], v[32:33]
  v_lshlrev_b32 v34, 16, v105
  v_and_b32 v35, 0xffff0000, v105
  v_pk_add_f32 v[26:27], v[26:27], v[34:35]
  v_lshlrev_b32 v32, 16, v106
  v_and_b32 v33, 0xffff0000, v106
  v_pk_add_f32 v[28:29], v[28:29], v[32:33]
  v_lshlrev_b32 v34, 16, v107
  v_and_b32 v35, 0xffff0000, v107
  v_pk_add_f32 v[30:31], v[30:31], v[34:35]
  s_waitcnt vmcnt(2)
  v_lshlrev_b32 v32, 16, v108
  v_and_b32 v33, 0xffff0000, v108
  v_pk_add_f32 v[24:25], v[24:25], v[32:33]
  v_lshlrev_b32 v34, 16, v109
  v_and_b32 v35, 0xffff0000, v109
  v_pk_add_f32 v[26:27], v[26:27], v[34:35]
  v_lshlrev_b32 v32, 16, v110
  v_and_b32 v33, 0xffff0000, v110
  v_pk_add_f32 v[28:29], v[28:29], v[32:33]
  v_lshlrev_b32 v34, 16, v111
  v_and_b32 v35, 0xffff0000, v111
  v_pk_add_f32 v[30:31], v[30:31], v[34:35]
  s_waitcnt vmcnt(1)
  v_lshlrev_b32 v32, 16, v112
  v_and_b32 v33, 0xffff0000, v112
  v_pk_add_f32 v[24:25], v[24:25], v[32:33]
  v_lshlrev_b32 v34, 16, v113
  v_and_b32 v35, 0xffff0000, v113
  v_pk_add_f32 v[26:27], v[26:27], v[34:35]
  v_lshlrev_b32 v32, 16, v114
  v_and_b32 v33, 0xffff0000, v114
  v_pk_add_f32 v[28:29], v[28:29], v[32:33]
  v_lshlrev_b32 v34, 16, v115
  v_and_b32 v35, 0xffff0000, v115
  v_pk_add_f32 v[30:31], v[30:31], v[34:35]
  s_waitcnt vmcnt(0)
  v_lshlrev_b32 v32, 16, v116
  v_and_b32 v33, 0xffff0000, v116
  v_pk_add_f32 v[24:25], v[24:25], v[32:33]
  v_lshlrev_b32 v34, 16, v117
  v_and_b32 v35, 0xffff0000, v117
  v_pk_add_f32 v[26:27], v[26:27], v[34:35]
  v_lshlrev_b32 v32, 16, v118
  v_and_b32 v33, 0xffff0000, v118
  v_pk_add_f32 v[28:29], v[28:29], v[32:33]
  v_lshlrev_b32 v34, 16, v119
  v_and_b32 v35, 0xffff0000, v119
  v_pk_add_f32 v[30:31], v[30:31], v[34:35]
  s_mov_b32 exec_hi, 0xff
  buffer_store_dwordx2 v[36:37], v14, s[36:39], s56 offen
  buffer_store_dwordx2 v[38:39], v14, s[36:39], s57 offen
  s_mov_b64 exec, -1
  v_cvt_pk_bf16_f32 v40, v24, v25
  v_cvt_pk_bf16_f32 v41, v26, v27
  v_cvt_pk_bf16_f32 v42, v28, v29
  v_cvt_pk_bf16_f32 v43, v30, v31
  s_mov_b64 exec, 0xffffffff
  buffer_store_dwordx2 v[40:41], v15, s[36:39], s56 offen
  buffer_store_dwordx2 v[42:43], v15, s[36:39], s57 offen
  s_mov_b64 exec, -1
L_end_standalone__mha_block_cached__near_ridge_kernel:
  s_endpgm
.section .rodata,"a"
.p2align 6
.amdhsa_kernel standalone__mha_block_cached__near_ridge_kernel
.amdhsa_next_free_vgpr 256
.amdhsa_next_free_sgpr 102
.amdhsa_accum_offset 256
.amdhsa_group_segment_fixed_size 0
.amdhsa_kernarg_size 64
.amdhsa_user_sgpr_count 2
.amdhsa_user_sgpr_kernarg_segment_ptr 1
.amdhsa_system_sgpr_workgroup_id_x 1
.end_amdhsa_kernel
```
